```python
import torch

def _softmax(x, axis=-1):
    return torch.softmax(x, dim=axis)
def _gelu(x):
    return torch.nn.functional.gelu(x, approximate="tanh")
def _silu(x):
    return torch.nn.functional.silu(x)
def _sigmoid(x):
    return torch.sigmoid(x)
def _layernorm(x, axis=-1, eps=1e-5):
    m = x.mean(dim=axis, keepdim=True)
    v = x.var(dim=axis, keepdim=True, unbiased=False)
    return (x - m) / torch.sqrt(v + eps)
def _scatter_add(tgt, idx, src, axis=0):
    return tgt.clone().index_add_(axis, idx, src)
def _segment_sum(src, seg, n):
    out = torch.zeros((n,) + src.shape[1:], dtype=src.dtype)
    return out.index_add_(0, seg, src)
def _pad(x, pw):
    flat = tuple(v for pair in reversed(pw) for v in pair)
    return torch.nn.functional.pad(x, flat)

kernel_name = 'parallel_sum__sliding_block_cached__glu_gated_reglu__decode'

def setup_inputs():

    _w = (lambda a: (lambda t: t.to(torch.bfloat16) if t.is_floating_point() else t)(torch.as_tensor(a)))
    def _A_setup():
        B, Sq, D = 4, 1, 448
        Hq, Hkv, Sk, Dh = 16, 8, 16384, 256
        assert Hq % Hkv == 0, (Hq, Hkv)
        return {
            "x": _w((lambda *s: torch.randn(*s, dtype=torch.bfloat16) * 0.05)(B, Sq, D)),
            "k_cache": _w((lambda *s: torch.randn(*s, dtype=torch.bfloat16) * 1.6)(B, Hkv, Sk, Dh)),
            "v_cache": _w((lambda *s: torch.randn(*s, dtype=torch.bfloat16) * 0.8)(B, Hkv, Sk, Dh)),
            "wq": _w((lambda *s: torch.randn(*s, dtype=torch.bfloat16) * 1.6)(D, Hq * Dh) * (D ** -0.5)),
            "wo": _w((lambda *s: torch.randn(*s, dtype=torch.bfloat16) * 0.8)(Hq * Dh, D) * ((Hq * Dh) ** -0.5)),
        }
    _A_in = _A_setup()

    def _B_setup():
        B, S, D, F = 4, 1, 448, 1792
        return {
            "x": _w((lambda *s: torch.randn(*s, dtype=torch.bfloat16) * 0.05)(B, S, D)),
            "W_gate": _w((lambda *s: torch.randn(*s, dtype=torch.bfloat16) * 0.4)(D, F) * (2.0 / D) ** 0.5),
            "W_up": _w((lambda *s: torch.randn(*s, dtype=torch.bfloat16) * 0.4)(D, F) * (2.0 / D) ** 0.5),
            "W_down": _w((lambda *s: torch.randn(*s, dtype=torch.bfloat16) * 0.4)(F, D) * (1.0 / F) ** 0.5),
        }
    _B_in = _B_setup()

    return {
        "A_x": _A_in["x"],
        "A_k_cache": _A_in["k_cache"],
        "A_v_cache": _A_in["v_cache"],
        "A_wq": _A_in["wq"],
        "A_wo": _A_in["wo"],
        "B_x": _B_in["x"],
        "B_W_gate": _B_in["W_gate"],
        "B_W_up": _B_in["W_up"],
        "B_W_down": _B_in["W_down"],
    }

def reference(A_x, A_k_cache, A_v_cache, A_wq, A_wo, B_x, B_W_gate, B_W_up, B_W_down):
    def _A_ref(x, k_cache, v_cache, wq, wo):
        B, Sq, D = x.shape
        Hq, Dh = 16, 256
        Hkv, Sk = k_cache.shape[1], k_cache.shape[2]
        W = min(4096, max(256, Sk // 4))
        rep = Hq // Hkv
        q = (lambda x, *d: x.permute(*d))((x @ wq).reshape(B, Sq, Hq, Dh), 0, 2, 1, 3)
        k = (lambda x, n, axis: torch.repeat_interleave(x, n, dim=axis))(k_cache[:, :, Sk - W:, :], rep, axis=1)
        v = (lambda x, n, axis: torch.repeat_interleave(x, n, dim=axis))(v_cache[:, :, Sk - W:, :], rep, axis=1)
        scores = torch.einsum("bhqd,bhkd->bhqk", q, k) * (Dh ** -0.5)
        p = _softmax(scores, axis=-1)
        o = torch.einsum("bhqk,bhkd->bhqd", p, v)
        return (lambda x, *d: x.permute(*d))(o, 0, 2, 1, 3).reshape(B, Sq, Hq * Dh) @ wo

    def _B_ref(x, W_gate, W_up, W_down):
        gate = torch.einsum("bsd,df->bsf", x, W_gate)
        up = torch.einsum("bsd,df->bsf", x, W_up)
        gate = gate * (lambda x, dt: x.to(dt))(gate > 0, gate.dtype)
        h = gate * up
        return torch.einsum("bsf,fd->bsd", h, W_down)

    x = A_x
    xn = _layernorm(x, axis=-1)
    return x + _A_ref(xn, A_k_cache, A_v_cache, A_wq, A_wo) + _B_ref(xn, B_W_gate, B_W_up, B_W_down)
```

```asm
; @launch grid=(256,1,1) block=(512,1,1) lds=62976
.amdgcn_target "amdgcn-amd-amdhsa--gfx950"
.text
.globl parallel_sum__sliding_block_cached__glu_gated_reglu__decode_kernel
.p2align 8
.type parallel_sum__sliding_block_cached__glu_gated_reglu__decode_kernel,@function
parallel_sum__sliding_block_cached__glu_gated_reglu__decode_kernel:
    s_cmp_ge_u32 s2, 256
    s_cbranch_scc1 L_end
    s_load_dwordx16 s[16:31], s[0:1], 0
    s_load_dwordx8 s[32:39], s[0:1], 64
    v_lshrrev_b32 v1, 6, v0
    s_and_b32 s4, s2, 31
    v_readfirstlane_b32 s3, v1
    v_and_b32 v1, 63, v0
    s_lshr_b32 s5, s2, 5
    v_lshrrev_b32 v176, 4, v1
    v_and_b32 v180, 15, v1
    s_cmp_lg_u32 s3, 0
    s_cbranch_scc1 L_stream
    s_setprio 3
    v_mov_b32 v40, 0
    v_mov_b32 v41, 0
    v_mov_b32 v42, 0
    v_mov_b32 v43, 0
    ds_write_b96 v43, v[40:42] offset:4608
    s_lshr_b32 s74, s2, 1
    s_bitcmp0_b32 s2, 0
    s_cbranch_scc1 L_even
    s_and_b32 s7, s74, -4
    s_add_u32 s74, s7, 67
    s_and_b32 s7, s2, 7
    s_cmp_lg_u32 s7, 1
    s_cselect_b32 s74, 127, s74
    s_mov_b32 s78, 11
    s_mov_b32 s79, 14
    s_cmp_lt_u32 s74, 120
    s_cbranch_scc1 L_task
    s_waitcnt lgkmcnt(0)
    s_branch L_wdone
L_even:
    s_and_b32 s7, s74, 0x43
    s_cmp_eq_u32 s7, 0x43
    s_cselect_b32 s79, 11, 14
    s_and_b32 s7, s74, 0x47
    s_cmp_eq_u32 s7, 3
    s_cselect_b32 s79, 7, s79
    s_lshl_b32 s7, s74, 3
    s_sub_u32 s7, s7, 957
    s_cmp_ge_u32 s74, 120
    s_cselect_b32 s74, s7, s74
    s_cselect_b32 s78, 7, 0
    s_cselect_b32 s79, 14, s79
L_task:
    v_mul_u32_u24 v182, 896, v176
    v_lshl_add_u32 v182, v180, 3, v182
    s_cmp_lt_u32 s74, 92
    s_cselect_b32 s81, 64, 92
    s_cmp_lt_u32 s74, 64
    s_cselect_b32 s81, 0, s81
    s_movk_i32 s7, 3584
    s_cselect_b32 s80, 8192, s7
    s_sub_u32 s81, s74, s81
    s_lshl_b32 s81, s81, 7
    s_mul_i32 s62, s80, 447
    s_add_u32 s62, s62, 128
    s_mov_b32 s63, 0x20000
    v_lshrrev_b32 v181, 3, v1
    v_mul_lo_u32 v181, v181, s80
    v_and_b32 v183, 7, v1
    v_lshl_add_u32 v181, v183, 4, v181
    s_lshl_b32 s82, s80, 3
    s_sub_u32 s83, s78, s79
    s_add_u32 s83, s83, 14
    s_lshl_b32 s7, s83, 12
    s_add_u32 m0, s7, 5632
    s_mul_i32 s7, s78, s82
    s_lshl_b32 s7, s7, 2
    s_cmp_lt_u32 s74, 92
    s_waitcnt lgkmcnt(0)
    global_load_dwordx2 v[16:17], v182, s[16:17] offset:0
    global_load_dwordx2 v[18:19], v182, s[16:17] offset:128
    global_load_dwordx2 v[20:21], v182, s[16:17] offset:256
    global_load_dwordx2 v[22:23], v182, s[16:17] offset:384
    global_load_dwordx2 v[24:25], v182, s[16:17] offset:512
    global_load_dwordx2 v[26:27], v182, s[16:17] offset:640
    global_load_dwordx2 v[28:29], v182, s[16:17] offset:768
    s_cselect_b32 s60, s28, s30
    s_cselect_b32 s61, s29, s31
    s_cmp_lt_u32 s74, 64
    s_cselect_b32 s60, s22, s60
    s_cselect_b32 s61, s23, s61
    s_add_u32 s60, s60, s81
    s_addc_u32 s61, s61, 0
L_wloop:
    buffer_load_dwordx4 v181, s[60:63], s7 offen nt lds
    s_add_u32 s7, s7, s82
    s_add_u32 m0, m0, 1024
    s_cmp_lt_u32 m0, 62976
    s_cbranch_scc1 L_wloop
L_wdone:
    s_load_dword s70, s[38:39], 0
    s_barrier
    s_branch L_service
L_stream:
    s_setprio 1
    s_cmp_lt_u32 s3, 4
    s_cbranch_scc1 L_nopref
    s_cmp_lt_u32 s2, 240
    s_cbranch_scc1 L_nopref
    s_getpc_b64 s[68:69]
    s_mul_i32 s7, s3, 3072
    v_lshlrev_b32 v179, 4, v1
    s_sub_u32 s7, s7, 11776
    v_add_u32 v179, s7, v179
    global_load_dwordx4 v[16:19], v179, s[68:69] offset:0
    global_load_dwordx4 v[20:23], v179, s[68:69] offset:1024
    global_load_dwordx4 v[24:27], v179, s[68:69] offset:2048
L_nopref:
    v_and_b32 v177, 3, v1
    v_bfe_u32 v178, v1, 2, 2
    v_lshlrev_b32 v2, 6, v176
    v_lshl_add_u32 v2, v177, 4, v2
    v_lshl_add_u32 v2, v178, 13, v2
    s_mul_i32 s87, s4, 5
    s_add_u32 s87, s87, s5
    s_lshl_b32 s87, s87, 9
    s_lshl_b32 s6, s4, 5
    s_add_u32 s6, s6, s5
    s_add_u32 s6, s6, 24
    s_lshl_b32 s6, s6, 3
    s_add_u32 s6, s6, s3
    s_lshl_b32 s6, s6, 15
    s_mov_b32 s10, 0x8000
    s_mov_b32 s11, 0x20000
    s_waitcnt lgkmcnt(0)
    s_add_u32 s8, s18, s6
    s_addc_u32 s9, s19, 0
    s_add_u32 s40, s87, 0
    s_and_b32 s40, s40, 0x1fff
    buffer_load_dwordx4 v[48:51], v2, s[8:11], s40 offen offset:0 nt
    buffer_load_dwordx4 v[52:55], v2, s[8:11], s40 offen offset:256 nt
    s_add_u32 s41, s87, 4096
    s_and_b32 s41, s41, 0x1fff
    buffer_load_dwordx4 v[56:59], v2, s[8:11], s41 offen offset:0 nt
    buffer_load_dwordx4 v[60:63], v2, s[8:11], s41 offen offset:256 nt
    s_barrier
    s_add_u32 s42, s87, 512
    s_and_b32 s42, s42, 0x1fff
    buffer_load_dwordx4 v[64:67], v2, s[8:11], s42 offen offset:0 nt
    buffer_load_dwordx4 v[68:71], v2, s[8:11], s42 offen offset:256 nt
    s_add_u32 s43, s87, 4608
    s_and_b32 s43, s43, 0x1fff
    buffer_load_dwordx4 v[72:75], v2, s[8:11], s43 offen offset:0 nt
    buffer_load_dwordx4 v[76:79], v2, s[8:11], s43 offen offset:256 nt
    s_add_u32 s44, s87, 1024
    s_and_b32 s44, s44, 0x1fff
    buffer_load_dwordx4 v[80:83], v2, s[8:11], s44 offen offset:0 nt
    buffer_load_dwordx4 v[84:87], v2, s[8:11], s44 offen offset:256 nt
    s_add_u32 s45, s87, 5120
    s_and_b32 s45, s45, 0x1fff
    buffer_load_dwordx4 v[88:91], v2, s[8:11], s45 offen offset:0 nt
    buffer_load_dwordx4 v[92:95], v2, s[8:11], s45 offen offset:256 nt
    s_add_u32 s46, s87, 1536
    s_and_b32 s46, s46, 0x1fff
    buffer_load_dwordx4 v[96:99], v2, s[8:11], s46 offen offset:0 nt
    buffer_load_dwordx4 v[100:103], v2, s[8:11], s46 offen offset:256 nt
    s_add_u32 s47, s87, 5632
    s_and_b32 s47, s47, 0x1fff
    buffer_load_dwordx4 v[104:107], v2, s[8:11], s47 offen offset:0 nt
    buffer_load_dwordx4 v[108:111], v2, s[8:11], s47 offen offset:256 nt
    s_add_u32 s48, s87, 2048
    s_and_b32 s48, s48, 0x1fff
    buffer_load_dwordx4 v[112:115], v2, s[8:11], s48 offen offset:0 nt
    buffer_load_dwordx4 v[116:119], v2, s[8:11], s48 offen offset:256 nt
    s_add_u32 s49, s87, 6144
    s_and_b32 s49, s49, 0x1fff
    buffer_load_dwordx4 v[120:123], v2, s[8:11], s49 offen offset:0 nt
    buffer_load_dwordx4 v[124:127], v2, s[8:11], s49 offen offset:256 nt
    s_add_u32 s50, s87, 2560
    s_and_b32 s50, s50, 0x1fff
    buffer_load_dwordx4 v[128:131], v2, s[8:11], s50 offen offset:0 nt
    buffer_load_dwordx4 v[132:135], v2, s[8:11], s50 offen offset:256 nt
    s_add_u32 s51, s87, 6656
    s_and_b32 s51, s51, 0x1fff
    buffer_load_dwordx4 v[136:139], v2, s[8:11], s51 offen offset:0 nt
    buffer_load_dwordx4 v[140:143], v2, s[8:11], s51 offen offset:256 nt
    s_add_u32 s52, s87, 3072
    s_and_b32 s52, s52, 0x1fff
    buffer_load_dwordx4 v[144:147], v2, s[8:11], s52 offen offset:0 nt
    buffer_load_dwordx4 v[148:151], v2, s[8:11], s52 offen offset:256 nt
    s_add_u32 s53, s87, 7168
    s_and_b32 s53, s53, 0x1fff
    buffer_load_dwordx4 v[152:155], v2, s[8:11], s53 offen offset:0 nt
    buffer_load_dwordx4 v[156:159], v2, s[8:11], s53 offen offset:256 nt
    s_add_u32 s54, s87, 3584
    s_and_b32 s54, s54, 0x1fff
    buffer_load_dwordx4 v[160:163], v2, s[8:11], s54 offen offset:0 nt
    buffer_load_dwordx4 v[164:167], v2, s[8:11], s54 offen offset:256 nt
    s_add_u32 s55, s87, 7680
    s_and_b32 s55, s55, 0x1fff
    buffer_load_dwordx4 v[168:171], v2, s[8:11], s55 offen offset:0 nt
    buffer_load_dwordx4 v[172:175], v2, s[8:11], s55 offen offset:256 nt
    s_and_b32 s73, s2, 7
    s_lshr_b32 s72, s4, 3
    s_lshl_b32 s27, s72, 3
    s_add_u32 s27, s27, s5
    s_mov_b32 s56, s38
    s_mov_b32 s57, s39
    s_mov_b32 s58, 589824
    s_mov_b32 s59, 0x20000
    v_lshlrev_b32 v3, 13, v176
    v_lshl_add_u32 v3, v180, 4, v3
    s_add_u32 s12, s20, s6
    s_addc_u32 s13, s21, 0
    s_mov_b32 s14, 0x8000
    s_mov_b32 s15, 0x20000
    v_and_b32 v177, 1, v1
    v_lshlrev_b32 v177, 4, v177
    v_mov_b32 v178, 0xffff
    v_lshlrev_b32 v177, v177, v178
    v_bfe_u32 v178, v1, 1, 2
    v_cmp_eq_u32 vcc, 0, v178
    s_nop 1
    v_cndmask_b32 v4, 0, v177, vcc
    v_cmp_eq_u32 vcc, 1, v178
    s_nop 1
    v_cndmask_b32 v5, 0, v177, vcc
    v_cmp_eq_u32 vcc, 2, v178
    s_nop 1
    v_cndmask_b32 v6, 0, v177, vcc
    v_cmp_eq_u32 vcc, 3, v178
    s_nop 1
    v_cndmask_b32 v7, 0, v177, vcc
    s_mov_b32 s76, 0x3db8aa3b
    s_movk_i32 s71, 0xff
    s_setprio 0
    v_mov_b32 v177, 0
    v_mov_b32 v178, 1
    s_mov_b64 exec, 1
    ds_add_u32 v177, v178 offset:4616
    s_mov_b64 exec, -1
L_issueV:
    v_mov_b32 v177, 0
    s_mov_b32 s77, 262144
L_ks:
    ds_read_b32 v178, v177 offset:4616
    s_waitcnt lgkmcnt(0)
    v_readfirstlane_b32 s7, v178
    s_sub_u32 s77, s77, 1
    s_cbranch_scc1 L_ks_go
    s_cmp_ge_u32 s7, 8
    s_cbranch_scc1 L_ks_go
    s_sleep 1
    s_branch L_ks
L_ks_go:
    buffer_load_dwordx4 v[184:187], v3, s[12:15], s40 offen offset:0 nt
    buffer_load_dwordx4 v[188:191], v3, s[12:15], s40 offen offset:256 nt
    s_nop 0
    buffer_load_dwordx4 v[192:195], v3, s[12:15], s41 offen offset:0 nt
    buffer_load_dwordx4 v[196:199], v3, s[12:15], s41 offen offset:256 nt
    s_nop 0
    buffer_load_dwordx4 v[200:203], v3, s[12:15], s42 offen offset:0 nt
    buffer_load_dwordx4 v[204:207], v3, s[12:15], s42 offen offset:256 nt
    s_nop 0
    buffer_load_dwordx4 v[208:211], v3, s[12:15], s43 offen offset:0 nt
    buffer_load_dwordx4 v[212:215], v3, s[12:15], s43 offen offset:256 nt
    s_nop 0
    buffer_load_dwordx4 v[216:219], v3, s[12:15], s44 offen offset:0 nt
    buffer_load_dwordx4 v[220:223], v3, s[12:15], s44 offen offset:256 nt
    s_nop 0
    buffer_load_dwordx4 v[224:227], v3, s[12:15], s45 offen offset:0 nt
    buffer_load_dwordx4 v[228:231], v3, s[12:15], s45 offen offset:256 nt
    s_nop 0
    buffer_load_dwordx4 v[232:235], v3, s[12:15], s46 offen offset:0 nt
    buffer_load_dwordx4 v[236:239], v3, s[12:15], s46 offen offset:256 nt
    s_nop 0
    buffer_load_dwordx4 v[240:243], v3, s[12:15], s47 offen offset:0 nt
    buffer_load_dwordx4 v[244:247], v3, s[12:15], s47 offen offset:256 nt
    s_nop 0
    v_mov_b32 v177, 0
    s_mov_b32 s77, 262144
L_qpoll:
    ds_read_b32 v178, v177 offset:4608
    s_waitcnt lgkmcnt(0)
    v_readfirstlane_b32 s7, v178
    s_sub_u32 s77, s77, 1
    s_cbranch_scc1 L_qpoll_go
    s_cmp_lg_u32 s7, 0
    s_cbranch_scc1 L_qpoll_go
    s_sleep 1
    s_branch L_qpoll
L_qpoll_go:
    ds_read_b32 v0, v177 offset:4628
    v_bfe_u32 v177, v1, 3, 1
    v_lshlrev_b32 v177, 9, v177
    v_lshrrev_b32 v178, 4, v1
    v_lshl_add_u32 v177, v178, 6, v177
    v_and_b32 v178, 3, v1
    v_lshl_add_u32 v177, v178, 4, v177
    ds_read_b128 v[8:11], v177 offset:0
    ds_read_b128 v[12:15], v177 offset:256
    s_waitcnt lgkmcnt(0)
    s_waitcnt vmcnt(40)
    v_mfma_f32_16x16x32_bf16 v[32:35], v[48:51], v[8:11], 0
    v_mfma_f32_16x16x32_bf16 v[32:35], v[52:55], v[12:15], v[32:35]
    v_mfma_f32_16x16x32_bf16 v[36:39], v[56:59], v[8:11], 0
    v_mfma_f32_16x16x32_bf16 v[36:39], v[60:63], v[12:15], v[36:39]
    v_mfma_f32_16x16x32_bf16 v[40:43], v[64:67], v[8:11], 0
    v_mfma_f32_16x16x32_bf16 v[40:43], v[68:71], v[12:15], v[40:43]
    v_mfma_f32_16x16x32_bf16 v[44:47], v[72:75], v[8:11], 0
    v_mfma_f32_16x16x32_bf16 v[44:47], v[76:79], v[12:15], v[44:47]
    buffer_load_dwordx4 v[248:251], v3, s[12:15], s48 offen offset:0 nt
    buffer_load_dwordx4 v[252:255], v3, s[12:15], s48 offen offset:256 nt
    s_nop 0
    s_nop 4
    v_mov_b32_dpp v16, v32 quad_perm:[0,0,0,0] row_mask:0xf bank_mask:0xf
    v_mov_b32_dpp v17, v36 quad_perm:[0,0,0,0] row_mask:0xf bank_mask:0xf
    v_mov_b32_dpp v18, v40 quad_perm:[0,0,0,0] row_mask:0xf bank_mask:0xf
    v_mov_b32_dpp v19, v44 quad_perm:[0,0,0,0] row_mask:0xf bank_mask:0xf
    v_add_f32_dpp v16, v33, v16 quad_perm:[1,1,1,1] row_mask:0xf bank_mask:0xf
    v_add_f32_dpp v17, v37, v17 quad_perm:[1,1,1,1] row_mask:0xf bank_mask:0xf
    v_add_f32_dpp v18, v41, v18 quad_perm:[1,1,1,1] row_mask:0xf bank_mask:0xf
    v_add_f32_dpp v19, v45, v19 quad_perm:[1,1,1,1] row_mask:0xf bank_mask:0xf
    v_add_f32_dpp v16, v34, v16 quad_perm:[2,2,2,2] row_mask:0xf bank_mask:0xf
    v_add_f32_dpp v17, v38, v17 quad_perm:[2,2,2,2] row_mask:0xf bank_mask:0xf
    v_add_f32_dpp v18, v42, v18 quad_perm:[2,2,2,2] row_mask:0xf bank_mask:0xf
    v_add_f32_dpp v19, v46, v19 quad_perm:[2,2,2,2] row_mask:0xf bank_mask:0xf
    v_add_f32_dpp v16, v35, v16 quad_perm:[3,3,3,3] row_mask:0xf bank_mask:0xf
    v_add_f32_dpp v17, v39, v17 quad_perm:[3,3,3,3] row_mask:0xf bank_mask:0xf
    v_add_f32_dpp v18, v43, v18 quad_perm:[3,3,3,3] row_mask:0xf bank_mask:0xf
    v_add_f32_dpp v19, v47, v19 quad_perm:[3,3,3,3] row_mask:0xf bank_mask:0xf
    s_waitcnt vmcnt(34)
    v_mfma_f32_16x16x32_bf16 v[32:35], v[80:83], v[8:11], 0
    v_mfma_f32_16x16x32_bf16 v[32:35], v[84:87], v[12:15], v[32:35]
    v_mfma_f32_16x16x32_bf16 v[36:39], v[88:91], v[8:11], 0
    v_mfma_f32_16x16x32_bf16 v[36:39], v[92:95], v[12:15], v[36:39]
    v_mfma_f32_16x16x32_bf16 v[40:43], v[96:99], v[8:11], 0
    v_mfma_f32_16x16x32_bf16 v[40:43], v[100:103], v[12:15], v[40:43]
    v_mfma_f32_16x16x32_bf16 v[44:47], v[104:107], v[8:11], 0
    v_mfma_f32_16x16x32_bf16 v[44:47], v[108:111], v[12:15], v[44:47]
    buffer_load_dwordx4 v[48:51], v3, s[12:15], s49 offen offset:0 nt
    buffer_load_dwordx4 v[52:55], v3, s[12:15], s49 offen offset:256 nt
    s_nop 0
    s_nop 4
    v_mov_b32_dpp v20, v32 quad_perm:[0,0,0,0] row_mask:0xf bank_mask:0xf
    v_mov_b32_dpp v21, v36 quad_perm:[0,0,0,0] row_mask:0xf bank_mask:0xf
    v_mov_b32_dpp v22, v40 quad_perm:[0,0,0,0] row_mask:0xf bank_mask:0xf
    v_mov_b32_dpp v23, v44 quad_perm:[0,0,0,0] row_mask:0xf bank_mask:0xf
    v_add_f32_dpp v20, v33, v20 quad_perm:[1,1,1,1] row_mask:0xf bank_mask:0xf
    v_add_f32_dpp v21, v37, v21 quad_perm:[1,1,1,1] row_mask:0xf bank_mask:0xf
    v_add_f32_dpp v22, v41, v22 quad_perm:[1,1,1,1] row_mask:0xf bank_mask:0xf
    v_add_f32_dpp v23, v45, v23 quad_perm:[1,1,1,1] row_mask:0xf bank_mask:0xf
    v_add_f32_dpp v20, v34, v20 quad_perm:[2,2,2,2] row_mask:0xf bank_mask:0xf
    v_add_f32_dpp v21, v38, v21 quad_perm:[2,2,2,2] row_mask:0xf bank_mask:0xf
    v_add_f32_dpp v22, v42, v22 quad_perm:[2,2,2,2] row_mask:0xf bank_mask:0xf
    v_add_f32_dpp v23, v46, v23 quad_perm:[2,2,2,2] row_mask:0xf bank_mask:0xf
    v_add_f32_dpp v20, v35, v20 quad_perm:[3,3,3,3] row_mask:0xf bank_mask:0xf
    v_add_f32_dpp v21, v39, v21 quad_perm:[3,3,3,3] row_mask:0xf bank_mask:0xf
    v_add_f32_dpp v22, v43, v22 quad_perm:[3,3,3,3] row_mask:0xf bank_mask:0xf
    v_add_f32_dpp v23, v47, v23 quad_perm:[3,3,3,3] row_mask:0xf bank_mask:0xf
    s_waitcnt vmcnt(28)
    v_mfma_f32_16x16x32_bf16 v[32:35], v[112:115], v[8:11], 0
    v_mfma_f32_16x16x32_bf16 v[32:35], v[116:119], v[12:15], v[32:35]
    v_mfma_f32_16x16x32_bf16 v[36:39], v[120:123], v[8:11], 0
    v_mfma_f32_16x16x32_bf16 v[36:39], v[124:127], v[12:15], v[36:39]
    v_mfma_f32_16x16x32_bf16 v[40:43], v[128:131], v[8:11], 0
    v_mfma_f32_16x16x32_bf16 v[40:43], v[132:135], v[12:15], v[40:43]
    v_mfma_f32_16x16x32_bf16 v[44:47], v[136:139], v[8:11], 0
    v_mfma_f32_16x16x32_bf16 v[44:47], v[140:143], v[12:15], v[44:47]
    buffer_load_dwordx4 v[56:59], v3, s[12:15], s50 offen offset:0 nt
    buffer_load_dwordx4 v[60:63], v3, s[12:15], s50 offen offset:256 nt
    s_nop 0
    s_nop 4
    v_mov_b32_dpp v24, v32 quad_perm:[0,0,0,0] row_mask:0xf bank_mask:0xf
    v_mov_b32_dpp v25, v36 quad_perm:[0,0,0,0] row_mask:0xf bank_mask:0xf
    v_mov_b32_dpp v26, v40 quad_perm:[0,0,0,0] row_mask:0xf bank_mask:0xf
    v_mov_b32_dpp v27, v44 quad_perm:[0,0,0,0] row_mask:0xf bank_mask:0xf
    v_add_f32_dpp v24, v33, v24 quad_perm:[1,1,1,1] row_mask:0xf bank_mask:0xf
    v_add_f32_dpp v25, v37, v25 quad_perm:[1,1,1,1] row_mask:0xf bank_mask:0xf
    v_add_f32_dpp v26, v41, v26 quad_perm:[1,1,1,1] row_mask:0xf bank_mask:0xf
    v_add_f32_dpp v27, v45, v27 quad_perm:[1,1,1,1] row_mask:0xf bank_mask:0xf
    v_add_f32_dpp v24, v34, v24 quad_perm:[2,2,2,2] row_mask:0xf bank_mask:0xf
    v_add_f32_dpp v25, v38, v25 quad_perm:[2,2,2,2] row_mask:0xf bank_mask:0xf
    v_add_f32_dpp v26, v42, v26 quad_perm:[2,2,2,2] row_mask:0xf bank_mask:0xf
    v_add_f32_dpp v27, v46, v27 quad_perm:[2,2,2,2] row_mask:0xf bank_mask:0xf
    v_add_f32_dpp v24, v35, v24 quad_perm:[3,3,3,3] row_mask:0xf bank_mask:0xf
    v_add_f32_dpp v25, v39, v25 quad_perm:[3,3,3,3] row_mask:0xf bank_mask:0xf
    v_add_f32_dpp v26, v43, v26 quad_perm:[3,3,3,3] row_mask:0xf bank_mask:0xf
    v_add_f32_dpp v27, v47, v27 quad_perm:[3,3,3,3] row_mask:0xf bank_mask:0xf
    s_waitcnt vmcnt(22)
    v_mfma_f32_16x16x32_bf16 v[32:35], v[144:147], v[8:11], 0
    v_mfma_f32_16x16x32_bf16 v[32:35], v[148:151], v[12:15], v[32:35]
    v_mfma_f32_16x16x32_bf16 v[36:39], v[152:155], v[8:11], 0
    v_mfma_f32_16x16x32_bf16 v[36:39], v[156:159], v[12:15], v[36:39]
    v_mfma_f32_16x16x32_bf16 v[40:43], v[160:163], v[8:11], 0
    v_mfma_f32_16x16x32_bf16 v[40:43], v[164:167], v[12:15], v[40:43]
    v_mfma_f32_16x16x32_bf16 v[44:47], v[168:171], v[8:11], 0
    v_mfma_f32_16x16x32_bf16 v[44:47], v[172:175], v[12:15], v[44:47]
    buffer_load_dwordx4 v[64:67], v3, s[12:15], s51 offen offset:0 nt
    buffer_load_dwordx4 v[68:71], v3, s[12:15], s51 offen offset:256 nt
    s_nop 0
    s_nop 4
    v_mov_b32_dpp v28, v32 quad_perm:[0,0,0,0] row_mask:0xf bank_mask:0xf
    v_mov_b32_dpp v29, v36 quad_perm:[0,0,0,0] row_mask:0xf bank_mask:0xf
    v_mov_b32_dpp v30, v40 quad_perm:[0,0,0,0] row_mask:0xf bank_mask:0xf
    v_mov_b32_dpp v31, v44 quad_perm:[0,0,0,0] row_mask:0xf bank_mask:0xf
    v_add_f32_dpp v28, v33, v28 quad_perm:[1,1,1,1] row_mask:0xf bank_mask:0xf
    v_add_f32_dpp v29, v37, v29 quad_perm:[1,1,1,1] row_mask:0xf bank_mask:0xf
    v_add_f32_dpp v30, v41, v30 quad_perm:[1,1,1,1] row_mask:0xf bank_mask:0xf
    v_add_f32_dpp v31, v45, v31 quad_perm:[1,1,1,1] row_mask:0xf bank_mask:0xf
    v_add_f32_dpp v28, v34, v28 quad_perm:[2,2,2,2] row_mask:0xf bank_mask:0xf
    v_add_f32_dpp v29, v38, v29 quad_perm:[2,2,2,2] row_mask:0xf bank_mask:0xf
    v_add_f32_dpp v30, v42, v30 quad_perm:[2,2,2,2] row_mask:0xf bank_mask:0xf
    v_add_f32_dpp v31, v46, v31 quad_perm:[2,2,2,2] row_mask:0xf bank_mask:0xf
    v_add_f32_dpp v28, v35, v28 quad_perm:[3,3,3,3] row_mask:0xf bank_mask:0xf
    v_add_f32_dpp v29, v39, v29 quad_perm:[3,3,3,3] row_mask:0xf bank_mask:0xf
    v_add_f32_dpp v30, v43, v30 quad_perm:[3,3,3,3] row_mask:0xf bank_mask:0xf
    v_add_f32_dpp v31, v47, v31 quad_perm:[3,3,3,3] row_mask:0xf bank_mask:0xf
    v_cvt_pk_bf16_f32 v17, v16, v17
    v_cvt_pk_bf16_f32 v19, v18, v19
    v_cvt_pk_bf16_f32 v21, v20, v21
    v_cvt_pk_bf16_f32 v23, v22, v23
    v_cvt_pk_bf16_f32 v25, v24, v25
    v_cvt_pk_bf16_f32 v27, v26, v27
    v_cvt_pk_bf16_f32 v29, v28, v29
    v_cvt_pk_bf16_f32 v31, v30, v31
    v_lshlrev_b32 v16, 16, v17
    v_and_b32 v17, 0xffff0000, v17
    v_lshlrev_b32 v18, 16, v19
    v_and_b32 v19, 0xffff0000, v19
    v_lshlrev_b32 v20, 16, v21
    v_and_b32 v21, 0xffff0000, v21
    v_lshlrev_b32 v22, 16, v23
    v_and_b32 v23, 0xffff0000, v23
    v_lshlrev_b32 v24, 16, v25
    v_and_b32 v25, 0xffff0000, v25
    v_lshlrev_b32 v26, 16, v27
    v_and_b32 v27, 0xffff0000, v27
    v_lshlrev_b32 v28, 16, v29
    v_and_b32 v29, 0xffff0000, v29
    v_lshlrev_b32 v30, 16, v31
    v_and_b32 v31, 0xffff0000, v31
    v_max3_f32 v180, v16, v17, v18
    v_max3_f32 v182, v19, v20, v21
    v_max3_f32 v180, v180, v22, v23
    v_max3_f32 v182, v182, v24, v25
    v_max3_f32 v180, v180, v26, v27
    v_max3_f32 v182, v182, v28, v29
    v_max3_f32 v180, v180, v30, v31
    v_max_f32 v180, v180, v182
    v_mov_b32 v182, v180
    s_nop 1
    v_permlane16_swap_b32 v180, v182
    s_nop 1
    v_max_f32 v180, v180, v182
    v_mov_b32 v182, v180
    s_nop 1
    v_permlane32_swap_b32 v180, v182
    s_nop 1
    v_max_f32 v180, v180, v182
    buffer_load_dwordx4 v[72:75], v3, s[12:15], s52 offen offset:0 nt
    buffer_load_dwordx4 v[76:79], v3, s[12:15], s52 offen offset:256 nt
    s_nop 0
    v_mul_f32 v180, s76, v180
    v_fma_f32 v16, v16, s76, -v180
    v_fma_f32 v17, v17, s76, -v180
    v_fma_f32 v18, v18, s76, -v180
    v_fma_f32 v19, v19, s76, -v180
    v_fma_f32 v20, v20, s76, -v180
    v_fma_f32 v21, v21, s76, -v180
    v_fma_f32 v22, v22, s76, -v180
    v_fma_f32 v23, v23, s76, -v180
    v_fma_f32 v24, v24, s76, -v180
    v_fma_f32 v25, v25, s76, -v180
    v_fma_f32 v26, v26, s76, -v180
    v_fma_f32 v27, v27, s76, -v180
    v_fma_f32 v28, v28, s76, -v180
    v_fma_f32 v29, v29, s76, -v180
    v_fma_f32 v30, v30, s76, -v180
    v_fma_f32 v31, v31, s76, -v180
    v_exp_f32 v16, v16
    v_exp_f32 v17, v17
    v_exp_f32 v18, v18
    v_exp_f32 v19, v19
    v_exp_f32 v20, v20
    v_exp_f32 v21, v21
    v_exp_f32 v22, v22
    v_exp_f32 v23, v23
    v_exp_f32 v24, v24
    v_exp_f32 v25, v25
    v_exp_f32 v26, v26
    v_exp_f32 v27, v27
    v_exp_f32 v28, v28
    v_exp_f32 v29, v29
    v_exp_f32 v30, v30
    v_exp_f32 v31, v31
    v_add_f32 v181, v16, v17
    v_add_f32 v182, v18, v19
    v_add_f32 v181, v181, v20
    v_add_f32 v182, v182, v21
    v_add_f32 v181, v181, v22
    v_add_f32 v182, v182, v23
    v_add_f32 v181, v181, v24
    v_add_f32 v182, v182, v25
    v_add_f32 v181, v181, v26
    v_add_f32 v182, v182, v27
    v_add_f32 v181, v181, v28
    v_add_f32 v182, v182, v29
    v_add_f32 v181, v181, v30
    v_add_f32 v182, v182, v31
    v_add_f32 v181, v181, v182
    v_cvt_pk_bf16_f32 v16, v16, v16
    v_cvt_pk_bf16_f32 v17, v17, v17
    v_cvt_pk_bf16_f32 v18, v18, v18
    v_cvt_pk_bf16_f32 v19, v19, v19
    v_cvt_pk_bf16_f32 v20, v20, v20
    v_cvt_pk_bf16_f32 v21, v21, v21
    v_cvt_pk_bf16_f32 v22, v22, v22
    v_cvt_pk_bf16_f32 v23, v23, v23
    v_cvt_pk_bf16_f32 v24, v24, v24
    v_cvt_pk_bf16_f32 v25, v25, v25
    v_cvt_pk_bf16_f32 v26, v26, v26
    v_cvt_pk_bf16_f32 v27, v27, v27
    v_cvt_pk_bf16_f32 v28, v28, v28
    v_cvt_pk_bf16_f32 v29, v29, v29
    v_cvt_pk_bf16_f32 v30, v30, v30
    v_cvt_pk_bf16_f32 v31, v31, v31
    v_mov_b32 v182, v181
    s_nop 1
    v_permlane16_swap_b32 v181, v182
    s_nop 1
    v_add_f32 v181, v181, v182
    v_mov_b32 v182, v181
    s_nop 1
    v_permlane32_swap_b32 v181, v182
    s_nop 1
    v_add_f32 v181, v181, v182
    v_bfe_u32 v182, v1, 3, 1
    v_lshlrev_b32 v182, 5, v182
    s_lshl_b32 s7, s3, 2
    v_add_u32 v182, s7, v182
    ds_write_b32 v182, v180 offset:4672
    ds_write_b32 v182, v181 offset:4736
    v_mov_b32 v177, 0
    v_mov_b32 v178, 1
    s_mov_b64 exec, 1
    ds_add_u32 v177, v178 offset:4612
    s_mov_b64 exec, -1
    v_and_b32 v40, v16, v4
    v_and_b32 v41, v16, v5
    v_and_b32 v42, v16, v6
    v_and_b32 v43, v16, v7
    buffer_load_dwordx4 v[80:83], v3, s[12:15], s53 offen offset:0 nt
    buffer_load_dwordx4 v[84:87], v3, s[12:15], s53 offen offset:256 nt
    s_nop 0
    v_and_b32 v44, v17, v4
    v_and_b32 v45, v17, v5
    v_and_b32 v46, v17, v6
    v_and_b32 v47, v17, v7
    s_waitcnt vmcnt(26)
    v_mfma_f32_16x16x32_bf16 v[32:35], v[40:43], v[184:187], 0
    v_mfma_f32_16x16x32_bf16 v[36:39], v[40:43], v[188:191], 0
    buffer_load_dwordx4 v[88:91], v3, s[12:15], s54 offen offset:0 nt
    buffer_load_dwordx4 v[92:95], v3, s[12:15], s54 offen offset:256 nt
    s_nop 0
    v_and_b32 v40, v18, v4
    v_and_b32 v41, v18, v5
    v_and_b32 v42, v18, v6
    v_and_b32 v43, v18, v7
    s_waitcnt vmcnt(26)
    v_mfma_f32_16x16x32_bf16 v[32:35], v[44:47], v[192:195], v[32:35]
    v_mfma_f32_16x16x32_bf16 v[36:39], v[44:47], v[196:199], v[36:39]
    buffer_load_dwordx4 v[96:99], v3, s[12:15], s55 offen offset:0 nt
    buffer_load_dwordx4 v[100:103], v3, s[12:15], s55 offen offset:256 nt
    s_nop 0
    v_lshrrev_b32 v156, 5, v1
    v_lshlrev_b32 v154, 8, v156
    v_lshlrev_b32 v156, 10, v156
    v_and_b32 v157, 15, v1
    v_lshl_add_u32 v156, v157, 5, v156
    v_bfe_u32 v158, v1, 4, 1
    v_lshl_add_u32 v156, v158, 4, v156
    s_lshl_b32 s7, s3, 11
    v_add_u32 v156, s7, v156
    s_lshl_b32 s78, s73, 2
    s_add_u32 s78, s78, s72
    s_and_b32 s79, s78, -2
    s_lshr_b32 s7, s3, 2
    s_add_u32 s79, s79, s7
    s_lshl_b32 s79, s79, 6
    s_add_u32 s79, s79, 4096
    s_lshl_b32 s78, s78, 3
    s_add_u32 s78, s78, s3
    s_lshl_b32 s78, s78, 10
    s_add_u32 s78, s78, 327680
    v_lshlrev_b32 v152, 4, v1
    v_and_b32 v153, 48, v1
    v_and_b32 v158, 31, v1
    v_lshl_add_u32 v154, v158, 2, v154
    s_lshl_b32 s7, s7, 1
    s_add_u32 s7, s7, s3
    s_lshl_b32 s7, s7, 9
    s_add_u32 s7, s7, 5632
    v_add_u32 v154, s7, v154
    s_lshr_b32 s7, s3, 2
    s_mul_i32 s7, s7, 3072
    s_and_b32 s6, s3, 3
    s_lshl_b32 s6, s6, 7
    s_add_u32 s7, s7, s6
    v_lshrrev_b32 v175, 1, v1
    v_lshlrev_b32 v150, 2, v175
    v_add_u32 v150, s7, v150
    s_lshr_b32 s7, s3, 1
    s_mul_i32 s7, s7, 7
    s_add_u32 s7, s7, s5
    s_lshl_b32 s7, s7, 1
    s_and_b32 s6, s3, 1
    s_add_u32 s7, s7, s6
    s_lshl_b32 s6, s7, 6
    v_lshlrev_b32 v175, 1, v175
    v_add_u32 v175, s6, v175
    s_lshl_b32 s7, s7, 8
    s_add_u32 s7, s7, 16384
    v_lshlrev_b32 v151, 2, v1
    v_add_u32 v151, s7, v151
    v_lshrrev_b32 v155, 4, v1
    v_lshlrev_b32 v155, 10, v155
    v_bfe_u32 v158, v1, 2, 2
    v_lshl_add_u32 v155, v158, 7, v155
    v_and_b32 v158, 3, v1
    v_lshl_add_u32 v155, v158, 3, v155
    s_and_b32 s7, s3, 3
    s_lshl_b32 s7, s7, 12
    s_add_u32 s7, s7, 28160
    v_add_u32 v155, s7, v155
    v_lshrrev_b32 v148, 3, v1
    v_mul_u32_u24 v148, 896, v148
    v_and_b32 v149, 7, v1
    v_lshl_add_u32 v148, v149, 4, v148
    s_lshl_b32 s6, s73, 2
    s_add_u32 s6, s6, s72
    s_and_b32 s7, s3, 3
    s_cmp_ge_u32 s3, 4
    s_cselect_b32 s60, s24, s32
    s_cselect_b32 s61, s25, s33
    s_cselect_b32 s80, 128, 56
    s_cselect_b32 s81, 0, 4
    s_mul_i32 s6, s6, s80
    s_add_u32 s81, s81, s7
    s_lshl_b32 s7, s7, 5
    s_add_u32 s6, s6, s7
    s_mul_i32 s6, s6, 7
    s_add_u32 s6, s6, s5
    s_lshl_b32 s6, s6, 7
    s_add_u32 s60, s60, s6
    s_addc_u32 s61, s61, 0
    s_lshl_b32 s81, s81, 12
    s_add_u32 s81, s81, 28160
    s_mov_b32 s62, 27904
    s_mov_b32 s63, 0x20000
    s_cmp_eq_u32 s3, 1
    s_cselect_b32 s62, 20736, s62
    s_lshr_b32 s7, s3, 1
    s_cmp_eq_u32 s7, 1
    s_cselect_b32 s62, 0, s62
    s_cmp_eq_u32 s5, 7
    s_cselect_b32 s62, 0, s62
    v_and_b32 v44, v19, v4
    v_and_b32 v45, v19, v5
    v_and_b32 v46, v19, v6
    v_and_b32 v47, v19, v7
    s_waitcnt vmcnt(26)
    v_mfma_f32_16x16x32_bf16 v[32:35], v[40:43], v[200:203], v[32:35]
    v_mfma_f32_16x16x32_bf16 v[36:39], v[40:43], v[204:207], v[36:39]
    v_and_b32 v40, v20, v4
    v_and_b32 v41, v20, v5
    v_and_b32 v42, v20, v6
    v_and_b32 v43, v20, v7
    s_waitcnt vmcnt(24)
    v_mfma_f32_16x16x32_bf16 v[32:35], v[44:47], v[208:211], v[32:35]
    v_mfma_f32_16x16x32_bf16 v[36:39], v[44:47], v[212:215], v[36:39]
    v_and_b32 v44, v21, v4
    v_and_b32 v45, v21, v5
    v_and_b32 v46, v21, v6
    v_and_b32 v47, v21, v7
    s_waitcnt vmcnt(22)
    v_mfma_f32_16x16x32_bf16 v[32:35], v[40:43], v[216:219], v[32:35]
    v_mfma_f32_16x16x32_bf16 v[36:39], v[40:43], v[220:223], v[36:39]
    v_and_b32 v40, v22, v4
    v_and_b32 v41, v22, v5
    v_and_b32 v42, v22, v6
    v_and_b32 v43, v22, v7
    s_waitcnt vmcnt(20)
    v_mfma_f32_16x16x32_bf16 v[32:35], v[44:47], v[224:227], v[32:35]
    v_mfma_f32_16x16x32_bf16 v[36:39], v[44:47], v[228:231], v[36:39]
    v_and_b32 v44, v23, v4
    v_and_b32 v45, v23, v5
    v_and_b32 v46, v23, v6
    v_and_b32 v47, v23, v7
    s_waitcnt vmcnt(18)
    v_mfma_f32_16x16x32_bf16 v[32:35], v[40:43], v[232:235], v[32:35]
    v_mfma_f32_16x16x32_bf16 v[36:39], v[40:43], v[236:239], v[36:39]
    v_and_b32 v40, v24, v4
    v_and_b32 v41, v24, v5
    v_and_b32 v42, v24, v6
    v_and_b32 v43, v24, v7
    s_waitcnt vmcnt(16)
    v_mfma_f32_16x16x32_bf16 v[32:35], v[44:47], v[240:243], v[32:35]
    v_mfma_f32_16x16x32_bf16 v[36:39], v[44:47], v[244:247], v[36:39]
    v_and_b32 v44, v25, v4
    v_and_b32 v45, v25, v5
    v_and_b32 v46, v25, v6
    v_and_b32 v47, v25, v7
    s_waitcnt vmcnt(14)
    v_mfma_f32_16x16x32_bf16 v[32:35], v[40:43], v[248:251], v[32:35]
    v_mfma_f32_16x16x32_bf16 v[36:39], v[40:43], v[252:255], v[36:39]
    v_and_b32 v40, v26, v4
    v_and_b32 v41, v26, v5
    v_and_b32 v42, v26, v6
    v_and_b32 v43, v26, v7
    s_waitcnt vmcnt(12)
    v_mfma_f32_16x16x32_bf16 v[32:35], v[44:47], v[48:51], v[32:35]
    v_mfma_f32_16x16x32_bf16 v[36:39], v[44:47], v[52:55], v[36:39]
    v_and_b32 v44, v27, v4
    v_and_b32 v45, v27, v5
    v_and_b32 v46, v27, v6
    v_and_b32 v47, v27, v7
    s_waitcnt vmcnt(10)
    v_mfma_f32_16x16x32_bf16 v[32:35], v[40:43], v[56:59], v[32:35]
    v_mfma_f32_16x16x32_bf16 v[36:39], v[40:43], v[60:63], v[36:39]
    v_and_b32 v40, v28, v4
    v_and_b32 v41, v28, v5
    v_and_b32 v42, v28, v6
    v_and_b32 v43, v28, v7
    s_waitcnt vmcnt(8)
    v_mfma_f32_16x16x32_bf16 v[32:35], v[44:47], v[64:67], v[32:35]
    v_mfma_f32_16x16x32_bf16 v[36:39], v[44:47], v[68:71], v[36:39]
    s_add_u32 m0, s81, 0
    s_nop 0
    buffer_load_dwordx4 v148, s[60:63], 0 offen nt lds
    s_add_u32 m0, s81, 1024
    v_add_u32 v148, 7168, v148
    buffer_load_dwordx4 v148, s[60:63], 0 offen nt lds
    s_add_u32 m0, s81, 2048
    v_add_u32 v148, 7168, v148
    buffer_load_dwordx4 v148, s[60:63], 0 offen nt lds
    s_add_u32 m0, s81, 3072
    v_add_u32 v148, 7168, v148
    buffer_load_dwordx4 v148, s[60:63], 0 offen nt lds
    v_and_b32 v44, v29, v4
    v_and_b32 v45, v29, v5
    v_and_b32 v46, v29, v6
    v_and_b32 v47, v29, v7
    s_waitcnt vmcnt(10)
    v_mfma_f32_16x16x32_bf16 v[32:35], v[40:43], v[72:75], v[32:35]
    v_mfma_f32_16x16x32_bf16 v[36:39], v[40:43], v[76:79], v[36:39]
    v_and_b32 v40, v30, v4
    v_and_b32 v41, v30, v5
    v_and_b32 v42, v30, v6
    v_and_b32 v43, v30, v7
    s_waitcnt vmcnt(8)
    v_mfma_f32_16x16x32_bf16 v[32:35], v[44:47], v[80:83], v[32:35]
    v_mfma_f32_16x16x32_bf16 v[36:39], v[44:47], v[84:87], v[36:39]
    v_and_b32 v44, v31, v4
    v_and_b32 v45, v31, v5
    v_and_b32 v46, v31, v6
    v_and_b32 v47, v31, v7
    s_waitcnt vmcnt(6)
    v_mfma_f32_16x16x32_bf16 v[32:35], v[40:43], v[88:91], v[32:35]
    v_mfma_f32_16x16x32_bf16 v[36:39], v[40:43], v[92:95], v[36:39]
    s_waitcnt vmcnt(4)
    v_mfma_f32_16x16x32_bf16 v[32:35], v[44:47], v[96:99], v[32:35]
    v_mfma_f32_16x16x32_bf16 v[36:39], v[44:47], v[100:103], v[36:39]
    s_cmp_ge_u32 s3, 4
    s_nop 6
    ds_write_b128 v156, v[32:35] offset:11776
    ds_write_b128 v156, v[36:39] offset:12288
    s_cbranch_scc1 L_upper
    v_mov_b32 v177, 0
    v_mov_b32 v178, 1
    s_mov_b64 exec, 1
    ds_add_u32 v177, v178 offset:4616
    s_mov_b64 exec, -1
    s_waitcnt vmcnt(0)
    s_getpc_b64 s[68:69]
    s_lshl_b32 s7, s3, 9
    v_lshlrev_b32 v160, 3, v1
    v_add_u32 v160, s7, v160
    global_load_dwordx2 v[164:165], v160, s[68:69]
    v_lshrrev_b32 v161, 2, v1
    v_lshlrev_b32 v161, 8, v161
    v_and_b32 v157, 3, v1
    v_lshl_add_u32 v161, v157, 2, v161
    s_lshl_b32 s80, s73, 2
    s_add_u32 s80, s80, s3
    s_lshl_b32 s80, s80, 1
    s_lshr_b32 s7, s72, 1
    s_add_u32 s80, s80, s7
    s_lshl_b32 s80, s80, 8
    s_and_b32 s7, s27, 15
    s_add_u32 s80, s80, s7
    s_lshl_b32 s80, s80, 4
    s_add_u32 s80, s80, 327680
    s_lshl_b32 s81, s73, 8
    s_lshl_b32 s7, s3, 6
    s_add_u32 s81, s81, s7
    s_lshl_b32 s7, s27, 2
    s_add_u32 s81, s81, s7
    s_add_u32 s81, s81, 4096
    v_mov_b32 v157, 0
    s_mov_b32 s77, 262144
L_cpoll:
    ds_read_b32 v159, v157 offset:4612
    s_waitcnt lgkmcnt(0)
    v_readfirstlane_b32 s7, v159
    s_sub_u32 s77, s77, 1
    s_cbranch_scc1 L_cpoll_go
    s_cmp_ge_u32 s7, 8
    s_cbranch_scc1 L_cpoll_go
    s_sleep 1
    s_branch L_cpoll
L_cpoll_go:
    buffer_load_dwordx4 v[140:143], v152, s[56:59], s78 offen sc1
    buffer_load_dwordx4 v[144:147], v153, s[56:59], s79 offen sc1
    s_add_u32 s7, s78, 4096
    buffer_load_dwordx4 v[168:171], v152, s[56:59], s7 offen sc1
    ds_read_b32 v162, v157 offset:4624
    s_lshr_b32 s7, s3, 1
    s_lshl_b32 s7, s7, 5
    v_mov_b32 v157, s7
    ds_read_b128 v[84:87], v157 offset:4672
    ds_read_b128 v[88:91], v157 offset:4688
    ds_read_b128 v[92:95], v157 offset:4736
    ds_read_b128 v[96:99], v157 offset:4752
    s_waitcnt lgkmcnt(0)
    v_readfirstlane_b32 s75, v162
    v_max3_f32 v180, v84, v85, v86
    v_max3_f32 v182, v87, v88, v89
    v_max3_f32 v180, v180, v90, v91
    v_max_f32 v180, v180, v182
    v_sub_f32 v84, v84, v180
    v_sub_f32 v85, v85, v180
    v_sub_f32 v86, v86, v180
    v_sub_f32 v87, v87, v180
    v_sub_f32 v88, v88, v180
    v_sub_f32 v89, v89, v180
    v_sub_f32 v90, v90, v180
    v_sub_f32 v91, v91, v180
    v_exp_f32 v84, v84
    v_exp_f32 v85, v85
    v_exp_f32 v86, v86
    v_exp_f32 v87, v87
    v_exp_f32 v88, v88
    v_exp_f32 v89, v89
    v_exp_f32 v90, v90
    v_exp_f32 v91, v91
    s_nop 0
    v_mul_f32 v181, v84, v92
    v_mul_f32 v182, v85, v93
    v_fmac_f32 v181, v86, v94
    v_fmac_f32 v182, v87, v95
    v_fmac_f32 v181, v88, v96
    v_fmac_f32 v182, v89, v97
    v_fmac_f32 v181, v90, v98
    v_fmac_f32 v182, v91, v99
    v_add_f32 v181, v181, v182
    v_rcp_f32 v182, v181
    v_log_f32 v181, v181
    s_nop 0
    v_add_f32 v181, v181, v180
    v_mul_f32 v84, v84, v182
    v_mul_f32 v85, v85, v182
    v_mul_f32 v86, v86, v182
    v_mul_f32 v87, v87, v182
    v_mul_f32 v88, v88, v182
    v_mul_f32 v89, v89, v182
    v_mul_f32 v90, v90, v182
    v_mul_f32 v91, v91, v182
    v_min_u32 v92, -2, v181
    s_bitcmp1_b32 s3, 0
    s_cbranch_scc1 L_nolse
    s_mov_b64 exec, 1
    s_cmp_eq_u32 s75, 1
    s_cbranch_scc1 L_lfast
    buffer_store_dword v92, v152, s[56:59], s81 offen sc1
    s_branch L_ldone
L_lfast:
    buffer_store_dword v92, v152, s[56:59], s81 offen
L_ldone:
    s_mov_b64 exec, -1
L_nolse:
    s_cmp_ge_u32 s3, 2
    s_cbranch_scc1 L_noffn
    v_bfe_u32 v158, v1, 3, 1
    v_lshl_add_u32 v158, v158, 7, v153
    s_lshl_b32 s7, s3, 6
    v_add_u32 v158, s7, v158
    ds_read_b128 v[64:67], v158 offset:4864
    ds_read_b128 v[68:71], v158 offset:5120
    ds_read_b64_tr_b16 v[48:49], v155 offset:16384
    ds_read_b64_tr_b16 v[50:51], v155 offset:16896
    ds_read_b64_tr_b16 v[52:53], v155 offset:16416
    ds_read_b64_tr_b16 v[54:55], v155 offset:16928
    ds_read_b64_tr_b16 v[56:57], v155 offset:16448
    ds_read_b64_tr_b16 v[58:59], v155 offset:16960
    ds_read_b64_tr_b16 v[60:61], v155 offset:16480
    ds_read_b64_tr_b16 v[62:63], v155 offset:16992
    v_bfe_u32 v157, v1, 4, 1
    v_cmp_eq_u32 vcc, 1, v157
    v_add_u32 v158, 2048, v154
    v_add_u32 v159, 5120, v154
    s_waitcnt lgkmcnt(0)
    v_mfma_f32_16x16x32_bf16 v[120:123], v[64:67], v[48:51], 0
    v_mfma_f32_16x16x32_bf16 v[124:127], v[64:67], v[52:55], 0
    v_mfma_f32_16x16x32_bf16 v[128:131], v[64:67], v[56:59], 0
    v_mfma_f32_16x16x32_bf16 v[132:135], v[64:67], v[60:63], 0
    v_mfma_f32_16x16x32_bf16 v[104:107], v[68:71], v[48:51], 0
    v_mfma_f32_16x16x32_bf16 v[108:111], v[68:71], v[52:55], 0
    v_mfma_f32_16x16x32_bf16 v[112:115], v[68:71], v[56:59], 0
    v_mfma_f32_16x16x32_bf16 v[116:119], v[68:71], v[60:63], 0
    s_nop 7
    v_cndmask_b32 v136, v120, v124, vcc
    v_cndmask_b32 v137, v128, v132, vcc
    v_cndmask_b32 v138, v104, v108, vcc
    v_cndmask_b32 v139, v112, v116, vcc
    ds_write2_b32 v158, v136, v137 offset0:0 offset1:32
    ds_write2_b32 v159, v138, v139 offset0:0 offset1:32
L_noffn:
    v_mov_b32 v157, 0
    s_mov_b32 s77, 262144
L_opoll:
    ds_read_b32 v136, v157 offset:4616
    s_waitcnt lgkmcnt(0)
    v_readfirstlane_b32 s7, v136
    s_sub_u32 s77, s77, 1
    s_cbranch_scc1 L_opoll_go
    s_cmp_ge_u32 s7, 12
    s_cbranch_scc1 L_opoll_go
    s_sleep 1
    s_branch L_opoll
L_opoll_go:
    ds_read_b64 v[184:185], v160 offset:11776
    ds_read_b64 v[186:187], v160 offset:13824
    ds_read_b64 v[188:189], v160 offset:15872
    ds_read_b64 v[190:191], v160 offset:17920
    s_waitcnt lgkmcnt(3)
    v_mul_f32 v32, v84, v184
    v_mul_f32 v33, v84, v185
    s_waitcnt lgkmcnt(2)
    v_fmac_f32 v32, v85, v186
    v_fmac_f32 v33, v85, v187
    s_waitcnt lgkmcnt(1)
    v_fmac_f32 v32, v86, v188
    v_fmac_f32 v33, v86, v189
    s_waitcnt lgkmcnt(0)
    v_fmac_f32 v32, v87, v190
    v_fmac_f32 v33, v87, v191
    s_cmp_eq_u32 s75, 1
    s_barrier
    ds_read_b64 v[192:193], v160 offset:19968
    ds_read_b64 v[194:195], v160 offset:22016
    ds_read_b64 v[196:197], v160 offset:24064
    ds_read_b64 v[198:199], v160 offset:26112
    s_waitcnt lgkmcnt(3)
    v_fmac_f32 v32, v88, v192
    v_fmac_f32 v33, v88, v193
    s_waitcnt lgkmcnt(2)
    v_fmac_f32 v32, v89, v194
    v_fmac_f32 v33, v89, v195
    s_waitcnt lgkmcnt(1)
    v_fmac_f32 v32, v90, v196
    v_fmac_f32 v33, v90, v197
    s_waitcnt lgkmcnt(0)
    v_fmac_f32 v32, v91, v198
    v_fmac_f32 v33, v91, v199
    v_cvt_pk_bf16_f32 v32, v32, v33
    v_min_u32 v32, -2, v32
    s_cbranch_scc1 L_ofast
    buffer_store_dword v32, v161, s[56:59], s80 offen sc1
    s_branch L_odone
L_ofast:
    buffer_store_dword v32, v161, s[56:59], s80 offen
L_odone:
    s_cmp_eq_u32 s5, 7
    s_cbranch_scc1 L_done
L_level2:
    s_mov_b32 s77, 262144
    s_barrier
    buffer_load_dwordx4 v[140:143], v152, s[56:59], s78 offen sc1
    buffer_load_dwordx4 v[144:147], v153, s[56:59], s79 offen sc1
    ds_read_b64_tr_b16 v[104:105], v155 offset:0
    ds_read_b64_tr_b16 v[106:107], v155 offset:512
    ds_read_b64_tr_b16 v[108:109], v155 offset:32
    ds_read_b64_tr_b16 v[110:111], v155 offset:544
    ds_read_b64_tr_b16 v[112:113], v155 offset:64
    ds_read_b64_tr_b16 v[114:115], v155 offset:576
    ds_read_b64_tr_b16 v[116:117], v155 offset:96
    ds_read_b64_tr_b16 v[118:119], v155 offset:608
    s_branch L_l2chk
L_l2poll:
    buffer_load_dwordx4 v[140:143], v152, s[56:59], s78 offen sc1
    buffer_load_dwordx4 v[144:147], v153, s[56:59], s79 offen sc1
L_l2chk:
    s_waitcnt vmcnt(0)
    v_max3_u32 v157, v140, v141, v142
    v_max3_u32 v157, v157, v143, v144
    v_max3_u32 v157, v157, v145, v146
    v_max_u32 v157, v157, v147
    v_cmp_eq_u32 vcc, -1, v157
    s_sub_u32 s77, s77, 1
    s_cbranch_scc1 L_l2go
    s_cbranch_vccnz L_l2poll
L_l2go:
    s_waitcnt lgkmcnt(0)
    v_mfma_f32_16x16x32_bf16 v[120:123], v[140:143], v[104:107], 0
    v_max3_f32 v157, v144, v145, v146
    v_max_f32 v157, v157, v147
    v_mov_b32 v158, v157
    v_mfma_f32_16x16x32_bf16 v[124:127], v[140:143], v[108:111], 0
    s_nop 0
    v_permlane16_swap_b32 v157, v158
    v_mfma_f32_16x16x32_bf16 v[128:131], v[140:143], v[112:115], 0
    v_max_f32 v157, v157, v158
    v_sub_f32 v144, v144, v157
    v_sub_f32 v145, v145, v157
    v_mfma_f32_16x16x32_bf16 v[132:135], v[140:143], v[116:119], 0
    v_sub_f32 v146, v146, v157
    v_sub_f32 v147, v147, v157
    v_exp_f32 v144, v144
    v_exp_f32 v145, v145
    v_exp_f32 v146, v146
    v_exp_f32 v147, v147
    v_add_f32 v157, v144, v145
    v_add_f32 v158, v146, v147
    v_add_f32 v157, v157, v158
    v_mov_b32 v158, v157
    v_mul_f32 v120, v120, v144
    v_mul_f32 v124, v124, v144
    v_mul_f32 v128, v128, v144
    v_mul_f32 v132, v132, v144
    v_permlane16_swap_b32 v157, v158
    v_fmac_f32 v120, v121, v145
    v_fmac_f32 v124, v125, v145
    v_fmac_f32 v128, v129, v145
    v_fmac_f32 v132, v133, v145
    v_add_f32 v157, v157, v158
    v_rcp_f32 v157, v157
    v_fmac_f32 v120, v122, v146
    v_fmac_f32 v124, v126, v146
    v_fmac_f32 v128, v130, v146
    v_fmac_f32 v132, v134, v146
    v_fmac_f32 v120, v123, v147
    v_fmac_f32 v124, v127, v147
    v_fmac_f32 v128, v131, v147
    v_fmac_f32 v132, v135, v147
    s_mov_b32 vcc_lo, 0xaaaaaaaa
    v_permlane16_swap_b32 v120, v124
    v_permlane16_swap_b32 v128, v132
    v_add_f32 v120, v120, v124
    v_add_f32 v128, v128, v132
    v_mul_f32 v120, v120, v157
    v_mul_f32 v128, v128, v157
    ds_write2_b32 v154, v120, v128 offset0:0 offset1:32
    s_mov_b32 vcc_hi, 0xaaaaaaaa
    s_waitcnt lgkmcnt(0)
    s_barrier
    ds_read2st64_b32 v[184:185], v150 offset0:22 offset1:24
    ds_read2st64_b32 v[186:187], v150 offset0:26 offset1:28
    ds_read2st64_b32 v[188:189], v150 offset0:30 offset1:32
    s_waitcnt lgkmcnt(2)
    v_add_f32 v32, v184, v185
    s_waitcnt lgkmcnt(1)
    v_add_f32 v33, v186, v187
    v_add_f32 v32, v32, v33
    s_waitcnt lgkmcnt(0)
    v_add_f32 v33, v188, v189
    v_add_f32 v32, v32, v33
    v_cndmask_b32 v32, v32, 1.0, vcc
    global_atomic_add_f32 v34, v151, v32, s[38:39] sc0 sc1
    v_mov_b32 v36, 0x41f80000
    s_waitcnt vmcnt(0)
    v_mov_b32_dpp v35, v34 quad_perm:[1,1,3,3] row_mask:0xf bank_mask:0xf
    v_add_f32 v32, v32, v34
    v_cmp_eq_f32 vcc, v35, v36
    v_cvt_pk_bf16_f32 v32, v32, v32
    s_and_b32 exec_lo, vcc_lo, 0x55555555
    s_and_b32 exec_hi, vcc_hi, 0x55555555
    s_cbranch_execz L_noout
    global_store_short v175, v32, s[34:35]
    v_cmpx_eq_u32 vcc, 0, v175
    s_nop 4
    s_cbranch_execz L_noout
    global_store_dword v175, v0, s[38:39] offset:0
L_noout:
    s_endpgm
L_upper:
    s_cmp_eq_u32 s5, 7
    s_waitcnt lgkmcnt(0)
    s_barrier
    s_cbranch_scc1 L_done
    s_waitcnt vmcnt(0)
    s_branch L_level2
L_done:
L_end:
    s_endpgm
L_service:
    v_and_b32 v177, 3, v1
    v_bfe_u32 v178, v1, 2, 2
    v_lshlrev_b32 v2, 6, v176
    v_lshl_add_u32 v2, v177, 4, v2
    v_lshl_add_u32 v2, v178, 13, v2
    s_mul_i32 s87, s4, 5
    s_add_u32 s87, s87, s5
    s_lshl_b32 s87, s87, 9
    s_lshl_b32 s6, s4, 5
    s_add_u32 s6, s6, s5
    s_add_u32 s6, s6, 24
    s_lshl_b32 s6, s6, 3
    s_add_u32 s6, s6, s3
    s_lshl_b32 s6, s6, 15
    s_mov_b32 s10, 0x8000
    s_mov_b32 s11, 0x20000
    s_add_u32 s8, s18, s6
    s_addc_u32 s9, s19, 0
    s_and_b32 s73, s2, 7
    s_lshr_b32 s72, s4, 3
    s_lshl_b32 s27, s72, 3
    s_add_u32 s27, s27, s5
    s_mov_b32 s56, s38
    s_mov_b32 s57, s39
    s_mov_b32 s58, 589824
    s_mov_b32 s59, 0x20000
    v_lshlrev_b32 v3, 13, v176
    v_lshl_add_u32 v3, v180, 4, v3
    s_add_u32 s12, s20, s6
    s_addc_u32 s13, s21, 0
    s_mov_b32 s14, 0x8000
    s_mov_b32 s15, 0x20000
    v_and_b32 v177, 1, v1
    v_lshlrev_b32 v177, 4, v177
    v_mov_b32 v178, 0xffff
    v_lshlrev_b32 v177, v177, v178
    v_bfe_u32 v178, v1, 1, 2
    v_cmp_eq_u32 vcc, 0, v178
    s_nop 1
    v_cndmask_b32 v4, 0, v177, vcc
    v_cmp_eq_u32 vcc, 1, v178
    s_nop 1
    v_cndmask_b32 v5, 0, v177, vcc
    v_cmp_eq_u32 vcc, 2, v178
    s_nop 1
    v_cndmask_b32 v6, 0, v177, vcc
    v_cmp_eq_u32 vcc, 3, v178
    s_nop 1
    v_cndmask_b32 v7, 0, v177, vcc
    s_mov_b32 s76, 0x3db8aa3b
    s_movk_i32 s71, 0xff
    v_lshlrev_b32 v181, 4, v1
    s_cmp_ge_u32 s74, 120
    s_cbranch_scc1 L_notask
    s_cmp_eq_u32 s83, 0
    s_cbranch_scc1 L_xw0
    s_waitcnt vmcnt(12)
L_xw0:
    s_waitcnt vmcnt(56)
    s_cmp_ge_u32 s2, 14
    s_cbranch_scc1 L_noacc
    s_bitcmp1_b32 s2, 0
    s_cbranch_scc1 L_noacc
    ds_write_b64 v182, v[16:17] offset:1024
    ds_write_b64 v182, v[18:19] offset:1152
    ds_write_b64 v182, v[20:21] offset:1280
    ds_write_b64 v182, v[22:23] offset:1408
    ds_write_b64 v182, v[24:25] offset:1536
    ds_write_b64 v182, v[26:27] offset:1664
    ds_write_b64 v182, v[28:29] offset:1792
    s_lshl_b32 s6, s74, 7
    s_add_u32 s6, s6, 1024
    v_mul_u32_u24 v183, 896, v176
    v_lshl_add_u32 v183, v180, 2, v183
    v_add_u32 v183, s6, v183
    ds_read2_b32 v[46:47], v183 offset0:0 offset1:16
    v_mul_u32_u24 v183, 3584, v176
    v_lshl_add_u32 v183, v180, 4, v183
    s_lshl_b32 s7, s74, 9
    s_add_u32 s7, s7, 16384
    v_mov_b32 v33, 0
    v_mov_b32 v35, 0
    v_mov_b32 v37, 0
    v_mov_b32 v39, 0
    s_waitcnt lgkmcnt(0)
    v_lshlrev_b32 v32, 16, v46
    v_and_b32 v34, 0xffff0000, v46
    v_lshlrev_b32 v36, 16, v47
    v_and_b32 v38, 0xffff0000, v47
    buffer_store_dwordx4 v[32:35], v183, s[56:59], s7 offen sc1
    buffer_store_dwordx4 v[36:39], v183, s[56:59], s7 offen offset:256 sc1
L_noacc:
    v_lshlrev_b32 v184, 16, v16
    v_and_b32 v185, 0xffff0000, v16
    v_lshlrev_b32 v186, 16, v17
    v_and_b32 v187, 0xffff0000, v17
    v_lshlrev_b32 v188, 16, v18
    v_and_b32 v189, 0xffff0000, v18
    v_lshlrev_b32 v190, 16, v19
    v_and_b32 v191, 0xffff0000, v19
    v_lshlrev_b32 v192, 16, v20
    v_and_b32 v193, 0xffff0000, v20
    v_lshlrev_b32 v194, 16, v21
    v_and_b32 v195, 0xffff0000, v21
    v_lshlrev_b32 v196, 16, v22
    v_and_b32 v197, 0xffff0000, v22
    v_lshlrev_b32 v198, 16, v23
    v_and_b32 v199, 0xffff0000, v23
    v_lshlrev_b32 v200, 16, v24
    v_and_b32 v201, 0xffff0000, v24
    v_lshlrev_b32 v202, 16, v25
    v_and_b32 v203, 0xffff0000, v25
    v_lshlrev_b32 v204, 16, v26
    v_and_b32 v205, 0xffff0000, v26
    v_lshlrev_b32 v206, 16, v27
    v_and_b32 v207, 0xffff0000, v27
    v_lshlrev_b32 v208, 16, v28
    v_and_b32 v209, 0xffff0000, v28
    v_lshlrev_b32 v210, 16, v29
    v_and_b32 v211, 0xffff0000, v29
    v_pk_add_f32 v[178:179], v[184:185], v[186:187]
    v_pk_add_f32 v[44:45], v[188:189], v[190:191]
    v_pk_add_f32 v[178:179], v[178:179], v[192:193]
    v_pk_add_f32 v[44:45], v[44:45], v[194:195]
    v_pk_add_f32 v[178:179], v[178:179], v[196:197]
    v_pk_add_f32 v[44:45], v[44:45], v[198:199]
    v_pk_add_f32 v[178:179], v[178:179], v[200:201]
    v_pk_add_f32 v[44:45], v[44:45], v[202:203]
    v_pk_add_f32 v[178:179], v[178:179], v[204:205]
    v_pk_add_f32 v[44:45], v[44:45], v[206:207]
    v_pk_add_f32 v[178:179], v[178:179], v[208:209]
    v_pk_add_f32 v[44:45], v[44:45], v[210:211]
    v_pk_add_f32 v[178:179], v[178:179], v[44:45]
    v_add_f32 v178, v178, v179
    s_nop 1
    v_add_f32_dpp v178, v178, v178 row_ror:8 row_mask:0xf bank_mask:0xf
    s_nop 1
    v_add_f32_dpp v178, v178, v178 row_ror:4 row_mask:0xf bank_mask:0xf
    s_nop 1
    v_add_f32_dpp v178, v178, v178 row_ror:2 row_mask:0xf bank_mask:0xf
    s_nop 1
    v_add_f32_dpp v178, v178, v178 row_ror:1 row_mask:0xf bank_mask:0xf
    v_mul_f32 v178, 0x3b124925, v178
    v_sub_f32 v212, v184, v178
    v_sub_f32 v213, v185, v178
    v_sub_f32 v214, v186, v178
    v_sub_f32 v215, v187, v178
    v_sub_f32 v216, v188, v178
    v_sub_f32 v217, v189, v178
    v_sub_f32 v218, v190, v178
    v_sub_f32 v219, v191, v178
    v_sub_f32 v220, v192, v178
    v_sub_f32 v221, v193, v178
    v_sub_f32 v222, v194, v178
    v_sub_f32 v223, v195, v178
    v_sub_f32 v224, v196, v178
    v_sub_f32 v225, v197, v178
    v_sub_f32 v226, v198, v178
    v_sub_f32 v227, v199, v178
    v_sub_f32 v228, v200, v178
    v_sub_f32 v229, v201, v178
    v_sub_f32 v230, v202, v178
    v_sub_f32 v231, v203, v178
    v_sub_f32 v232, v204, v178
    v_sub_f32 v233, v205, v178
    v_sub_f32 v234, v206, v178
    v_sub_f32 v235, v207, v178
    v_sub_f32 v236, v208, v178
    v_sub_f32 v237, v209, v178
    v_sub_f32 v238, v210, v178
    v_sub_f32 v239, v211, v178
    v_mul_f32 v179, v212, v212
    v_mul_f32 v44, v213, v213
    v_fmac_f32 v179, v214, v214
    v_fmac_f32 v44, v215, v215
    v_fmac_f32 v179, v216, v216
    v_fmac_f32 v44, v217, v217
    v_fmac_f32 v179, v218, v218
    v_fmac_f32 v44, v219, v219
    v_fmac_f32 v179, v220, v220
    v_fmac_f32 v44, v221, v221
    v_fmac_f32 v179, v222, v222
    v_fmac_f32 v44, v223, v223
    v_fmac_f32 v179, v224, v224
    v_fmac_f32 v44, v225, v225
    v_fmac_f32 v179, v226, v226
    v_fmac_f32 v44, v227, v227
    v_fmac_f32 v179, v228, v228
    v_fmac_f32 v44, v229, v229
    v_fmac_f32 v179, v230, v230
    v_fmac_f32 v44, v231, v231
    v_fmac_f32 v179, v232, v232
    v_fmac_f32 v44, v233, v233
    v_fmac_f32 v179, v234, v234
    v_fmac_f32 v44, v235, v235
    v_fmac_f32 v179, v236, v236
    v_fmac_f32 v44, v237, v237
    v_fmac_f32 v179, v238, v238
    v_fmac_f32 v44, v239, v239
    v_add_f32 v179, v179, v44
    s_nop 1
    v_add_f32_dpp v179, v179, v179 row_ror:8 row_mask:0xf bank_mask:0xf
    s_nop 1
    v_add_f32_dpp v179, v179, v179 row_ror:4 row_mask:0xf bank_mask:0xf
    s_nop 1
    v_add_f32_dpp v179, v179, v179 row_ror:2 row_mask:0xf bank_mask:0xf
    s_nop 1
    v_add_f32_dpp v179, v179, v179 row_ror:1 row_mask:0xf bank_mask:0xf
    v_mul_f32 v179, 0x3b124925, v179
    v_cvt_pk_bf16_f32 v178, v178, v178
    v_and_b32 v178, 0xffff0000, v178
    v_cvt_pk_bf16_f32 v179, v179, v179
    v_and_b32 v179, 0xffff0000, v179
    v_add_f32 v179, 0x3727c5ac, v179
    v_cvt_pk_bf16_f32 v179, v179, v179
    v_and_b32 v179, 0xffff0000, v179
    v_sqrt_f32 v179, v179
    s_nop 0
    v_cvt_pk_bf16_f32 v179, v179, v179
    v_and_b32 v179, 0xffff0000, v179
    v_rcp_f32 v179, v179
    v_sub_f32 v212, v184, v178
    v_sub_f32 v213, v185, v178
    v_sub_f32 v214, v186, v178
    v_sub_f32 v215, v187, v178
    v_sub_f32 v216, v188, v178
    v_sub_f32 v217, v189, v178
    v_sub_f32 v218, v190, v178
    v_sub_f32 v219, v191, v178
    v_sub_f32 v220, v192, v178
    v_sub_f32 v221, v193, v178
    v_sub_f32 v222, v194, v178
    v_sub_f32 v223, v195, v178
    v_sub_f32 v224, v196, v178
    v_sub_f32 v225, v197, v178
    v_sub_f32 v226, v198, v178
    v_sub_f32 v227, v199, v178
    v_sub_f32 v228, v200, v178
    v_sub_f32 v229, v201, v178
    v_sub_f32 v230, v202, v178
    v_sub_f32 v231, v203, v178
    v_sub_f32 v232, v204, v178
    v_sub_f32 v233, v205, v178
    v_sub_f32 v234, v206, v178
    v_sub_f32 v235, v207, v178
    v_sub_f32 v236, v208, v178
    v_sub_f32 v237, v209, v178
    v_sub_f32 v238, v210, v178
    v_sub_f32 v239, v211, v178
    v_cvt_pk_bf16_f32 v184, v212, v213
    v_cvt_pk_bf16_f32 v185, v214, v215
    v_cvt_pk_bf16_f32 v186, v216, v217
    v_cvt_pk_bf16_f32 v187, v218, v219
    v_cvt_pk_bf16_f32 v188, v220, v221
    v_cvt_pk_bf16_f32 v189, v222, v223
    v_cvt_pk_bf16_f32 v190, v224, v225
    v_cvt_pk_bf16_f32 v191, v226, v227
    v_cvt_pk_bf16_f32 v192, v228, v229
    v_cvt_pk_bf16_f32 v193, v230, v231
    v_cvt_pk_bf16_f32 v194, v232, v233
    v_cvt_pk_bf16_f32 v195, v234, v235
    v_cvt_pk_bf16_f32 v196, v236, v237
    v_cvt_pk_bf16_f32 v197, v238, v239
    v_lshlrev_b32 v212, 16, v184
    v_and_b32 v213, 0xffff0000, v184
    v_lshlrev_b32 v214, 16, v185
    v_and_b32 v215, 0xffff0000, v185
    v_lshlrev_b32 v216, 16, v186
    v_and_b32 v217, 0xffff0000, v186
    v_lshlrev_b32 v218, 16, v187
    v_and_b32 v219, 0xffff0000, v187
    v_lshlrev_b32 v220, 16, v188
    v_and_b32 v221, 0xffff0000, v188
    v_lshlrev_b32 v222, 16, v189
    v_and_b32 v223, 0xffff0000, v189
    v_lshlrev_b32 v224, 16, v190
    v_and_b32 v225, 0xffff0000, v190
    v_lshlrev_b32 v226, 16, v191
    v_and_b32 v227, 0xffff0000, v191
    v_lshlrev_b32 v228, 16, v192
    v_and_b32 v229, 0xffff0000, v192
    v_lshlrev_b32 v230, 16, v193
    v_and_b32 v231, 0xffff0000, v193
    v_lshlrev_b32 v232, 16, v194
    v_and_b32 v233, 0xffff0000, v194
    v_lshlrev_b32 v234, 16, v195
    v_and_b32 v235, 0xffff0000, v195
    v_lshlrev_b32 v236, 16, v196
    v_and_b32 v237, 0xffff0000, v196
    v_lshlrev_b32 v238, 16, v197
    v_and_b32 v239, 0xffff0000, v197
    v_mul_f32 v212, v212, v179
    v_mul_f32 v213, v213, v179
    v_mul_f32 v214, v214, v179
    v_mul_f32 v215, v215, v179
    v_mul_f32 v216, v216, v179
    v_mul_f32 v217, v217, v179
    v_mul_f32 v218, v218, v179
    v_mul_f32 v219, v219, v179
    v_mul_f32 v220, v220, v179
    v_mul_f32 v221, v221, v179
    v_mul_f32 v222, v222, v179
    v_mul_f32 v223, v223, v179
    v_mul_f32 v224, v224, v179
    v_mul_f32 v225, v225, v179
    v_mul_f32 v226, v226, v179
    v_mul_f32 v227, v227, v179
    v_mul_f32 v228, v228, v179
    v_mul_f32 v229, v229, v179
    v_mul_f32 v230, v230, v179
    v_mul_f32 v231, v231, v179
    v_mul_f32 v232, v232, v179
    v_mul_f32 v233, v233, v179
    v_mul_f32 v234, v234, v179
    v_mul_f32 v235, v235, v179
    v_mul_f32 v236, v236, v179
    v_mul_f32 v237, v237, v179
    v_mul_f32 v238, v238, v179
    v_mul_f32 v239, v239, v179
    v_cvt_pk_bf16_f32 v184, v212, v213
    v_cvt_pk_bf16_f32 v185, v214, v215
    v_cvt_pk_bf16_f32 v186, v216, v217
    v_cvt_pk_bf16_f32 v187, v218, v219
    v_cvt_pk_bf16_f32 v188, v220, v221
    v_cvt_pk_bf16_f32 v189, v222, v223
    v_cvt_pk_bf16_f32 v190, v224, v225
    v_cvt_pk_bf16_f32 v191, v226, v227
    v_cvt_pk_bf16_f32 v192, v228, v229
    v_cvt_pk_bf16_f32 v193, v230, v231
    v_cvt_pk_bf16_f32 v194, v232, v233
    v_cvt_pk_bf16_f32 v195, v234, v235
    v_cvt_pk_bf16_f32 v196, v236, v237
    v_cvt_pk_bf16_f32 v197, v238, v239
    ds_write_b64 v182, v[184:185] offset:1024
    ds_write_b64 v182, v[186:187] offset:1152
    ds_write_b64 v182, v[188:189] offset:1280
    ds_write_b64 v182, v[190:191] offset:1408
    ds_write_b64 v182, v[192:193] offset:1536
    ds_write_b64 v182, v[194:195] offset:1664
    ds_write_b64 v182, v[196:197] offset:1792
    v_bfe_u32 v183, v1, 2, 2
    v_mul_u32_u24 v183, 896, v183
    v_lshl_add_u32 v183, v176, 4, v183
    s_sub_u32 s7, 14, s79
    s_lshl_b32 s7, s7, 6
    s_sub_u32 s7, 1024, s7
    v_add_u32 v183, s7, v183
    v_lshrrev_b32 v177, 4, v1
    v_lshlrev_b32 v177, 10, v177
    v_bfe_u32 v178, v1, 2, 2
    v_lshl_add_u32 v177, v178, 7, v177
    v_and_b32 v178, 3, v1
    v_lshl_add_u32 v177, v178, 3, v177
    v_add_u32 v177, 5632, v177
    s_waitcnt lgkmcnt(0)
    ds_read_b128 v[184:187], v183 offset:0
    ds_read_b128 v[188:191], v183 offset:64
    ds_read_b128 v[192:195], v183 offset:128
    ds_read_b128 v[196:199], v183 offset:192
    ds_read_b128 v[200:203], v183 offset:256
    ds_read_b128 v[204:207], v183 offset:320
    ds_read_b128 v[208:211], v183 offset:384
    ds_read_b128 v[212:215], v183 offset:448
    ds_read_b128 v[216:219], v183 offset:512
    ds_read_b128 v[220:223], v183 offset:576
    ds_read_b128 v[224:227], v183 offset:640
    ds_read_b128 v[228:231], v183 offset:704
    ds_read_b128 v[232:235], v183 offset:768
    ds_read_b128 v[236:239], v183 offset:832
    s_add_u32 s70, s70, 0x01010101
    v_mov_b32 v0, s70
    v_bfe_u32 v8, v0, 0, 8
    v_bfe_u32 v9, v0, 8, 8
    v_bfe_u32 v10, v0, 16, 8
    v_bfe_u32 v11, v0, 24, 8
    v_mov_b32 v32, 0
    v_mov_b32 v33, 0
    v_mov_b32 v34, 0
    v_mov_b32 v35, 0
    v_mov_b32 v36, 0
    v_mov_b32 v37, 0
    v_mov_b32 v38, 0
    v_mov_b32 v39, 0
    v_mov_b32 v40, 0
    v_mov_b32 v41, 0
    v_mov_b32 v42, 0
    v_mov_b32 v43, 0
    v_mov_b32 v44, 0
    v_mov_b32 v45, 0
    v_mov_b32 v46, 0
    v_mov_b32 v47, 0
    s_waitcnt lgkmcnt(0)
    s_cmp_eq_u32 s83, 3
    s_cbranch_scc1 L_ent3
    s_cmp_eq_u32 s83, 7
    s_cbranch_scc1 L_ent7
    s_cmp_eq_u32 s83, 11
    s_cbranch_scc1 L_ent11
    s_waitcnt vmcnt(52)
    ds_read_b64_tr_b16 v[48:49], v177 offset:0
    ds_read_b64_tr_b16 v[50:51], v177 offset:512
    ds_read_b64_tr_b16 v[52:53], v177 offset:32
    ds_read_b64_tr_b16 v[54:55], v177 offset:544
    ds_read_b64_tr_b16 v[56:57], v177 offset:64
    ds_read_b64_tr_b16 v[58:59], v177 offset:576
    ds_read_b64_tr_b16 v[60:61], v177 offset:96
    ds_read_b64_tr_b16 v[62:63], v177 offset:608
    s_waitcnt vmcnt(48)
    s_waitcnt lgkmcnt(0)
    ds_read_b64_tr_b16 v[64:65], v177 offset:4096
    ds_read_b64_tr_b16 v[66:67], v177 offset:4608
    ds_read_b64_tr_b16 v[68:69], v177 offset:4128
    ds_read_b64_tr_b16 v[70:71], v177 offset:4640
    ds_read_b64_tr_b16 v[72:73], v177 offset:4160
    ds_read_b64_tr_b16 v[74:75], v177 offset:4672
    ds_read_b64_tr_b16 v[76:77], v177 offset:4192
    ds_read_b64_tr_b16 v[78:79], v177 offset:4704
    v_mfma_f32_16x16x32_bf16 v[32:35], v[48:51], v[184:187], v[32:35]
    v_mfma_f32_16x16x32_bf16 v[36:39], v[52:55], v[184:187], v[36:39]
    v_mfma_f32_16x16x32_bf16 v[40:43], v[56:59], v[184:187], v[40:43]
    v_mfma_f32_16x16x32_bf16 v[44:47], v[60:63], v[184:187], v[44:47]
    s_waitcnt vmcnt(44)
    s_waitcnt lgkmcnt(0)
    ds_read_b64_tr_b16 v[48:49], v177 offset:8192
    ds_read_b64_tr_b16 v[50:51], v177 offset:8704
    ds_read_b64_tr_b16 v[52:53], v177 offset:8224
    ds_read_b64_tr_b16 v[54:55], v177 offset:8736
    ds_read_b64_tr_b16 v[56:57], v177 offset:8256
    ds_read_b64_tr_b16 v[58:59], v177 offset:8768
    ds_read_b64_tr_b16 v[60:61], v177 offset:8288
    ds_read_b64_tr_b16 v[62:63], v177 offset:8800
    v_mfma_f32_16x16x32_bf16 v[32:35], v[64:67], v[188:191], v[32:35]
    v_mfma_f32_16x16x32_bf16 v[36:39], v[68:71], v[188:191], v[36:39]
    v_mfma_f32_16x16x32_bf16 v[40:43], v[72:75], v[188:191], v[40:43]
    v_mfma_f32_16x16x32_bf16 v[44:47], v[76:79], v[188:191], v[44:47]
    s_waitcnt vmcnt(40)
    s_waitcnt lgkmcnt(0)
    ds_read_b64_tr_b16 v[64:65], v177 offset:12288
    ds_read_b64_tr_b16 v[66:67], v177 offset:12800
    ds_read_b64_tr_b16 v[68:69], v177 offset:12320
    ds_read_b64_tr_b16 v[70:71], v177 offset:12832
    ds_read_b64_tr_b16 v[72:73], v177 offset:12352
    ds_read_b64_tr_b16 v[74:75], v177 offset:12864
    ds_read_b64_tr_b16 v[76:77], v177 offset:12384
    ds_read_b64_tr_b16 v[78:79], v177 offset:12896
    v_mfma_f32_16x16x32_bf16 v[32:35], v[48:51], v[192:195], v[32:35]
    v_mfma_f32_16x16x32_bf16 v[36:39], v[52:55], v[192:195], v[36:39]
    v_mfma_f32_16x16x32_bf16 v[40:43], v[56:59], v[192:195], v[40:43]
    v_mfma_f32_16x16x32_bf16 v[44:47], v[60:63], v[192:195], v[44:47]
    s_branch L_it3
L_ent3:
    s_waitcnt vmcnt(40)
    ds_read_b64_tr_b16 v[64:65], v177 offset:12288
    ds_read_b64_tr_b16 v[66:67], v177 offset:12800
    ds_read_b64_tr_b16 v[68:69], v177 offset:12320
    ds_read_b64_tr_b16 v[70:71], v177 offset:12832
    ds_read_b64_tr_b16 v[72:73], v177 offset:12352
    ds_read_b64_tr_b16 v[74:75], v177 offset:12864
    ds_read_b64_tr_b16 v[76:77], v177 offset:12384
    ds_read_b64_tr_b16 v[78:79], v177 offset:12896
L_it3:
    s_waitcnt vmcnt(36)
    s_waitcnt lgkmcnt(0)
    ds_read_b64_tr_b16 v[48:49], v177 offset:16384
    ds_read_b64_tr_b16 v[50:51], v177 offset:16896
    ds_read_b64_tr_b16 v[52:53], v177 offset:16416
    ds_read_b64_tr_b16 v[54:55], v177 offset:16928
    ds_read_b64_tr_b16 v[56:57], v177 offset:16448
    ds_read_b64_tr_b16 v[58:59], v177 offset:16960
    ds_read_b64_tr_b16 v[60:61], v177 offset:16480
    ds_read_b64_tr_b16 v[62:63], v177 offset:16992
    v_mfma_f32_16x16x32_bf16 v[32:35], v[64:67], v[196:199], v[32:35]
    v_mfma_f32_16x16x32_bf16 v[36:39], v[68:71], v[196:199], v[36:39]
    v_mfma_f32_16x16x32_bf16 v[40:43], v[72:75], v[196:199], v[40:43]
    v_mfma_f32_16x16x32_bf16 v[44:47], v[76:79], v[196:199], v[44:47]
    s_waitcnt vmcnt(32)
    s_waitcnt lgkmcnt(0)
    ds_read_b64_tr_b16 v[64:65], v177 offset:20480
    ds_read_b64_tr_b16 v[66:67], v177 offset:20992
    ds_read_b64_tr_b16 v[68:69], v177 offset:20512
    ds_read_b64_tr_b16 v[70:71], v177 offset:21024
    ds_read_b64_tr_b16 v[72:73], v177 offset:20544
    ds_read_b64_tr_b16 v[74:75], v177 offset:21056
    ds_read_b64_tr_b16 v[76:77], v177 offset:20576
    ds_read_b64_tr_b16 v[78:79], v177 offset:21088
    v_mfma_f32_16x16x32_bf16 v[32:35], v[48:51], v[200:203], v[32:35]
    v_mfma_f32_16x16x32_bf16 v[36:39], v[52:55], v[200:203], v[36:39]
    v_mfma_f32_16x16x32_bf16 v[40:43], v[56:59], v[200:203], v[40:43]
    v_mfma_f32_16x16x32_bf16 v[44:47], v[60:63], v[200:203], v[44:47]
    s_waitcnt vmcnt(28)
    s_waitcnt lgkmcnt(0)
    ds_read_b64_tr_b16 v[48:49], v177 offset:24576
    ds_read_b64_tr_b16 v[50:51], v177 offset:25088
    ds_read_b64_tr_b16 v[52:53], v177 offset:24608
    ds_read_b64_tr_b16 v[54:55], v177 offset:25120
    ds_read_b64_tr_b16 v[56:57], v177 offset:24640
    ds_read_b64_tr_b16 v[58:59], v177 offset:25152
    ds_read_b64_tr_b16 v[60:61], v177 offset:24672
    ds_read_b64_tr_b16 v[62:63], v177 offset:25184
    v_mfma_f32_16x16x32_bf16 v[32:35], v[64:67], v[204:207], v[32:35]
    v_mfma_f32_16x16x32_bf16 v[36:39], v[68:71], v[204:207], v[36:39]
    v_mfma_f32_16x16x32_bf16 v[40:43], v[72:75], v[204:207], v[40:43]
    v_mfma_f32_16x16x32_bf16 v[44:47], v[76:79], v[204:207], v[44:47]
    s_waitcnt vmcnt(24)
    s_waitcnt lgkmcnt(0)
    ds_read_b64_tr_b16 v[64:65], v177 offset:28672
    ds_read_b64_tr_b16 v[66:67], v177 offset:29184
    ds_read_b64_tr_b16 v[68:69], v177 offset:28704
    ds_read_b64_tr_b16 v[70:71], v177 offset:29216
    ds_read_b64_tr_b16 v[72:73], v177 offset:28736
    ds_read_b64_tr_b16 v[74:75], v177 offset:29248
    ds_read_b64_tr_b16 v[76:77], v177 offset:28768
    ds_read_b64_tr_b16 v[78:79], v177 offset:29280
    v_mfma_f32_16x16x32_bf16 v[32:35], v[48:51], v[208:211], v[32:35]
    v_mfma_f32_16x16x32_bf16 v[36:39], v[52:55], v[208:211], v[36:39]
    v_mfma_f32_16x16x32_bf16 v[40:43], v[56:59], v[208:211], v[40:43]
    v_mfma_f32_16x16x32_bf16 v[44:47], v[60:63], v[208:211], v[44:47]
    s_branch L_it7
L_ent7:
    s_waitcnt vmcnt(24)
    ds_read_b64_tr_b16 v[64:65], v177 offset:28672
    ds_read_b64_tr_b16 v[66:67], v177 offset:29184
    ds_read_b64_tr_b16 v[68:69], v177 offset:28704
    ds_read_b64_tr_b16 v[70:71], v177 offset:29216
    ds_read_b64_tr_b16 v[72:73], v177 offset:28736
    ds_read_b64_tr_b16 v[74:75], v177 offset:29248
    ds_read_b64_tr_b16 v[76:77], v177 offset:28768
    ds_read_b64_tr_b16 v[78:79], v177 offset:29280
L_it7:
    s_waitcnt vmcnt(20)
    s_waitcnt lgkmcnt(0)
    ds_read_b64_tr_b16 v[48:49], v177 offset:32768
    ds_read_b64_tr_b16 v[50:51], v177 offset:33280
    ds_read_b64_tr_b16 v[52:53], v177 offset:32800
    ds_read_b64_tr_b16 v[54:55], v177 offset:33312
    ds_read_b64_tr_b16 v[56:57], v177 offset:32832
    ds_read_b64_tr_b16 v[58:59], v177 offset:33344
    ds_read_b64_tr_b16 v[60:61], v177 offset:32864
    ds_read_b64_tr_b16 v[62:63], v177 offset:33376
    v_mfma_f32_16x16x32_bf16 v[32:35], v[64:67], v[212:215], v[32:35]
    v_mfma_f32_16x16x32_bf16 v[36:39], v[68:71], v[212:215], v[36:39]
    v_mfma_f32_16x16x32_bf16 v[40:43], v[72:75], v[212:215], v[40:43]
    v_mfma_f32_16x16x32_bf16 v[44:47], v[76:79], v[212:215], v[44:47]
    s_waitcnt vmcnt(16)
    s_waitcnt lgkmcnt(0)
    ds_read_b64_tr_b16 v[64:65], v177 offset:36864
    ds_read_b64_tr_b16 v[66:67], v177 offset:37376
    ds_read_b64_tr_b16 v[68:69], v177 offset:36896
    ds_read_b64_tr_b16 v[70:71], v177 offset:37408
    ds_read_b64_tr_b16 v[72:73], v177 offset:36928
    ds_read_b64_tr_b16 v[74:75], v177 offset:37440
    ds_read_b64_tr_b16 v[76:77], v177 offset:36960
    ds_read_b64_tr_b16 v[78:79], v177 offset:37472
    v_mfma_f32_16x16x32_bf16 v[32:35], v[48:51], v[216:219], v[32:35]
    v_mfma_f32_16x16x32_bf16 v[36:39], v[52:55], v[216:219], v[36:39]
    v_mfma_f32_16x16x32_bf16 v[40:43], v[56:59], v[216:219], v[40:43]
    v_mfma_f32_16x16x32_bf16 v[44:47], v[60:63], v[216:219], v[44:47]
    s_waitcnt vmcnt(12)
    s_waitcnt lgkmcnt(0)
    ds_read_b64_tr_b16 v[48:49], v177 offset:40960
    ds_read_b64_tr_b16 v[50:51], v177 offset:41472
    ds_read_b64_tr_b16 v[52:53], v177 offset:40992
    ds_read_b64_tr_b16 v[54:55], v177 offset:41504
    ds_read_b64_tr_b16 v[56:57], v177 offset:41024
    ds_read_b64_tr_b16 v[58:59], v177 offset:41536
    ds_read_b64_tr_b16 v[60:61], v177 offset:41056
    ds_read_b64_tr_b16 v[62:63], v177 offset:41568
    v_mfma_f32_16x16x32_bf16 v[32:35], v[64:67], v[220:223], v[32:35]
    v_mfma_f32_16x16x32_bf16 v[36:39], v[68:71], v[220:223], v[36:39]
    v_mfma_f32_16x16x32_bf16 v[40:43], v[72:75], v[220:223], v[40:43]
    v_mfma_f32_16x16x32_bf16 v[44:47], v[76:79], v[220:223], v[44:47]
    s_waitcnt vmcnt(8)
    s_waitcnt lgkmcnt(0)
    ds_read_b64_tr_b16 v[64:65], v177 offset:45056
    ds_read_b64_tr_b16 v[66:67], v177 offset:45568
    ds_read_b64_tr_b16 v[68:69], v177 offset:45088
    ds_read_b64_tr_b16 v[70:71], v177 offset:45600
    ds_read_b64_tr_b16 v[72:73], v177 offset:45120
    ds_read_b64_tr_b16 v[74:75], v177 offset:45632
    ds_read_b64_tr_b16 v[76:77], v177 offset:45152
    ds_read_b64_tr_b16 v[78:79], v177 offset:45664
    v_mfma_f32_16x16x32_bf16 v[32:35], v[48:51], v[224:227], v[32:35]
    v_mfma_f32_16x16x32_bf16 v[36:39], v[52:55], v[224:227], v[36:39]
    v_mfma_f32_16x16x32_bf16 v[40:43], v[56:59], v[224:227], v[40:43]
    v_mfma_f32_16x16x32_bf16 v[44:47], v[60:63], v[224:227], v[44:47]
    s_branch L_it11
L_ent11:
    s_waitcnt vmcnt(8)
    ds_read_b64_tr_b16 v[64:65], v177 offset:45056
    ds_read_b64_tr_b16 v[66:67], v177 offset:45568
    ds_read_b64_tr_b16 v[68:69], v177 offset:45088
    ds_read_b64_tr_b16 v[70:71], v177 offset:45600
    ds_read_b64_tr_b16 v[72:73], v177 offset:45120
    ds_read_b64_tr_b16 v[74:75], v177 offset:45632
    ds_read_b64_tr_b16 v[76:77], v177 offset:45152
    ds_read_b64_tr_b16 v[78:79], v177 offset:45664
L_it11:
    s_waitcnt vmcnt(4)
    s_waitcnt lgkmcnt(0)
    ds_read_b64_tr_b16 v[48:49], v177 offset:49152
    ds_read_b64_tr_b16 v[50:51], v177 offset:49664
    ds_read_b64_tr_b16 v[52:53], v177 offset:49184
    ds_read_b64_tr_b16 v[54:55], v177 offset:49696
    ds_read_b64_tr_b16 v[56:57], v177 offset:49216
    ds_read_b64_tr_b16 v[58:59], v177 offset:49728
    ds_read_b64_tr_b16 v[60:61], v177 offset:49248
    ds_read_b64_tr_b16 v[62:63], v177 offset:49760
    v_mfma_f32_16x16x32_bf16 v[32:35], v[64:67], v[228:231], v[32:35]
    v_mfma_f32_16x16x32_bf16 v[36:39], v[68:71], v[228:231], v[36:39]
    v_mfma_f32_16x16x32_bf16 v[40:43], v[72:75], v[228:231], v[40:43]
    v_mfma_f32_16x16x32_bf16 v[44:47], v[76:79], v[228:231], v[44:47]
    s_waitcnt vmcnt(0)
    s_waitcnt lgkmcnt(0)
    ds_read_b64_tr_b16 v[64:65], v177 offset:53248
    ds_read_b64_tr_b16 v[66:67], v177 offset:53760
    ds_read_b64_tr_b16 v[68:69], v177 offset:53280
    ds_read_b64_tr_b16 v[70:71], v177 offset:53792
    ds_read_b64_tr_b16 v[72:73], v177 offset:53312
    ds_read_b64_tr_b16 v[74:75], v177 offset:53824
    ds_read_b64_tr_b16 v[76:77], v177 offset:53344
    ds_read_b64_tr_b16 v[78:79], v177 offset:53856
    v_mfma_f32_16x16x32_bf16 v[32:35], v[48:51], v[232:235], v[32:35]
    v_mfma_f32_16x16x32_bf16 v[36:39], v[52:55], v[232:235], v[36:39]
    v_mfma_f32_16x16x32_bf16 v[40:43], v[56:59], v[232:235], v[40:43]
    v_mfma_f32_16x16x32_bf16 v[44:47], v[60:63], v[232:235], v[44:47]
    s_waitcnt lgkmcnt(0)
    v_mfma_f32_16x16x32_bf16 v[32:35], v[64:67], v[236:239], v[32:35]
    v_mfma_f32_16x16x32_bf16 v[36:39], v[68:71], v[236:239], v[36:39]
    v_mfma_f32_16x16x32_bf16 v[40:43], v[72:75], v[236:239], v[40:43]
    v_mfma_f32_16x16x32_bf16 v[44:47], v[76:79], v[236:239], v[44:47]
    s_lshl_b32 s7, s74, 8
    s_add_u32 s7, s7, 65536
    s_lshr_b32 s6, s74, 2
    s_lshl_b32 s6, s6, 8
    s_add_u32 s6, s6, 196608
    s_cmp_eq_u32 s78, 0
    s_cselect_b32 s7, s7, s6
    v_and_b32 v178, 3, v1
    v_cmp_eq_u32 s[78:79], 1, v178
    v_cmp_eq_u32 s[80:81], 2, v178
    v_cmp_eq_u32 s[82:83], 3, v178
    v_bfe_u32 v179, v1, 2, 2
    v_lshlrev_b32 v179, 15, v179
    v_lshl_add_u32 v179, v176, 6, v179
    v_lshl_add_u32 v179, v178, 4, v179
    v_cndmask_b32 v32, v32, v36, s[78:79]
    v_cndmask_b32 v33, v33, v37, s[78:79]
    v_cndmask_b32 v34, v34, v38, s[78:79]
    v_cndmask_b32 v35, v35, v39, s[78:79]
    v_cndmask_b32 v32, v32, v40, s[80:81]
    v_cndmask_b32 v33, v33, v41, s[80:81]
    v_cndmask_b32 v34, v34, v42, s[80:81]
    v_cndmask_b32 v35, v35, v43, s[80:81]
    v_cndmask_b32 v32, v32, v44, s[82:83]
    v_cndmask_b32 v33, v33, v45, s[82:83]
    v_cndmask_b32 v34, v34, v46, s[82:83]
    v_cndmask_b32 v35, v35, v47, s[82:83]
    v_bfi_b32 v32, s71, v8, v32
    v_bfi_b32 v33, s71, v9, v33
    v_bfi_b32 v34, s71, v10, v34
    v_bfi_b32 v35, s71, v11, v35
    buffer_store_dwordx4 v[32:35], v179, s[56:59], s7 offen sc1
    s_cmp_ge_u32 s2, 14
    s_cbranch_scc1 L_svc3
    s_bitcmp1_b32 s2, 0
    s_cbranch_scc1 L_svc3
    s_lshl_b32 s7, s74, 7
    s_add_u32 s7, s7, 8192
    s_mov_b64 exec, 0xff
    buffer_store_dwordx4 v[32:35], v181, s[56:59], s7 offen sc1
    s_mov_b64 exec, -1
    s_branch L_svc3
L_notask:
    s_waitcnt lgkmcnt(0)
    s_add_u32 s70, s70, 0x01010101
    v_mov_b32 v0, s70
    v_bfe_u32 v8, v0, 0, 8
    v_bfe_u32 v9, v0, 8, 8
    v_bfe_u32 v10, v0, 16, 8
    v_bfe_u32 v11, v0, 24, 8
L_svc3:
    v_mov_b32 v40, -1
    v_mov_b32 v41, -1
    v_mov_b32 v42, -1
    v_mov_b32 v43, -1
    s_lshl_b32 s7, s73, 5
    s_add_u32 s7, s7, s27
    s_lshl_b32 s7, s7, 10
    s_add_u32 s7, s7, 327680
    buffer_store_dwordx4 v[40:43], v181, s[56:59], s7 offen
    s_cmp_lg_u32 s27, 31
    s_cbranch_scc1 L_nosclr
    s_lshl_b32 s7, s73, 8
    s_add_u32 s7, s7, 4096
    s_mov_b64 exec, 0xffff
    buffer_store_dwordx4 v[40:43], v181, s[56:59], s7 offen
    s_mov_b64 exec, -1
L_nosclr:
    s_add_u32 s40, s87, 0
    s_and_b32 s40, s40, 0x1fff
    buffer_load_dwordx4 v[48:51], v2, s[8:11], s40 offen offset:0 nt
    buffer_load_dwordx4 v[52:55], v2, s[8:11], s40 offen offset:256 nt
    s_add_u32 s41, s87, 4096
    s_and_b32 s41, s41, 0x1fff
    buffer_load_dwordx4 v[56:59], v2, s[8:11], s41 offen offset:0 nt
    buffer_load_dwordx4 v[60:63], v2, s[8:11], s41 offen offset:256 nt
    s_add_u32 s42, s87, 512
    s_and_b32 s42, s42, 0x1fff
    buffer_load_dwordx4 v[64:67], v2, s[8:11], s42 offen offset:0 nt
    buffer_load_dwordx4 v[68:71], v2, s[8:11], s42 offen offset:256 nt
    s_add_u32 s43, s87, 4608
    s_and_b32 s43, s43, 0x1fff
    buffer_load_dwordx4 v[72:75], v2, s[8:11], s43 offen offset:0 nt
    buffer_load_dwordx4 v[76:79], v2, s[8:11], s43 offen offset:256 nt
    s_getreg_b32 s83, hwreg(HW_REG_XCC_ID)
    s_and_b32 s83, s83, 15
    s_lshl_b32 s83, s83, 16
    v_or_b32 v40, s83, v8
    v_or_b32 v41, s83, v9
    v_or_b32 v42, s83, v10
    v_or_b32 v43, s83, v11
    s_lshl_b32 s84, s73, 12
    s_add_u32 s84, s84, 32768
    s_lshl_b32 s85, s27, 7
    s_add_u32 s85, s85, s84
    s_add_u32 s44, s87, 1024
    s_and_b32 s44, s44, 0x1fff
    buffer_load_dwordx4 v[80:83], v2, s[8:11], s44 offen offset:0 nt
    buffer_load_dwordx4 v[84:87], v2, s[8:11], s44 offen offset:256 nt
    s_add_u32 s45, s87, 5120
    s_and_b32 s45, s45, 0x1fff
    buffer_load_dwordx4 v[88:91], v2, s[8:11], s45 offen offset:0 nt
    buffer_load_dwordx4 v[92:95], v2, s[8:11], s45 offen offset:256 nt
    s_waitcnt vmcnt(12)
    s_mov_b64 exec, 0xff
    buffer_store_dwordx4 v[40:43], v181, s[56:59], s85 offen
    s_mov_b64 exec, -1
    s_add_u32 s46, s87, 1536
    s_and_b32 s46, s46, 0x1fff
    buffer_load_dwordx4 v[96:99], v2, s[8:11], s46 offen offset:0 nt
    buffer_load_dwordx4 v[100:103], v2, s[8:11], s46 offen offset:256 nt
    s_add_u32 s47, s87, 5632
    s_and_b32 s47, s47, 0x1fff
    buffer_load_dwordx4 v[104:107], v2, s[8:11], s47 offen offset:0 nt
    buffer_load_dwordx4 v[108:111], v2, s[8:11], s47 offen offset:256 nt
    s_add_u32 s48, s87, 2048
    s_and_b32 s48, s48, 0x1fff
    buffer_load_dwordx4 v[112:115], v2, s[8:11], s48 offen offset:0 nt
    buffer_load_dwordx4 v[116:119], v2, s[8:11], s48 offen offset:256 nt
    s_add_u32 s49, s87, 6144
    s_and_b32 s49, s49, 0x1fff
    buffer_load_dwordx4 v[120:123], v2, s[8:11], s49 offen offset:0 nt
    buffer_load_dwordx4 v[124:127], v2, s[8:11], s49 offen offset:256 nt
    s_add_u32 s50, s87, 2560
    s_and_b32 s50, s50, 0x1fff
    buffer_load_dwordx4 v[128:131], v2, s[8:11], s50 offen offset:0 nt
    buffer_load_dwordx4 v[132:135], v2, s[8:11], s50 offen offset:256 nt
    s_add_u32 s51, s87, 6656
    s_and_b32 s51, s51, 0x1fff
    buffer_load_dwordx4 v[136:139], v2, s[8:11], s51 offen offset:0 nt
    buffer_load_dwordx4 v[140:143], v2, s[8:11], s51 offen offset:256 nt
    s_add_u32 s52, s87, 3072
    s_and_b32 s52, s52, 0x1fff
    buffer_load_dwordx4 v[144:147], v2, s[8:11], s52 offen offset:0 nt
    buffer_load_dwordx4 v[148:151], v2, s[8:11], s52 offen offset:256 nt
    s_add_u32 s53, s87, 7168
    s_and_b32 s53, s53, 0x1fff
    buffer_load_dwordx4 v[152:155], v2, s[8:11], s53 offen offset:0 nt
    buffer_load_dwordx4 v[156:159], v2, s[8:11], s53 offen offset:256 nt
    s_add_u32 s54, s87, 3584
    s_and_b32 s54, s54, 0x1fff
    buffer_load_dwordx4 v[160:163], v2, s[8:11], s54 offen offset:0 nt
    buffer_load_dwordx4 v[164:167], v2, s[8:11], s54 offen offset:256 nt
    s_add_u32 s55, s87, 7680
    s_and_b32 s55, s55, 0x1fff
    buffer_load_dwordx4 v[168:171], v2, s[8:11], s55 offen offset:0 nt
    buffer_load_dwordx4 v[172:175], v2, s[8:11], s55 offen offset:256 nt
    v_mov_b32 v177, 0
    v_mov_b32 v178, 1
    s_mov_b64 exec, 1
    ds_add_u32 v177, v178 offset:4616
    s_mov_b64 exec, -1
    s_lshl_b32 s78, s73, 11
    s_lshl_b32 s7, s72, 15
    s_add_u32 s78, s78, s7
    s_add_u32 s78, s78, 65536
    s_add_u32 s79, s78, 1024
    s_lshl_b32 s64, s73, 9
    s_add_u32 s64, s64, s7
    s_add_u32 s64, s64, 196608
    v_lshlrev_b32 v17, 7, v176
    v_and_b32 v20, 3, v1
    v_lshl_add_u32 v17, v20, 5, v17
    v_bfe_u32 v20, v1, 2, 2
    v_lshl_add_u32 v17, v20, 3, v17
    v_lshlrev_b32 v19, 6, v1
    v_lshlrev_b32 v24, 4, v180
    v_and_b32 v22, 0x70, v24
    v_min_u32 v20, 13, v180
    s_lshl_b32 s7, s73, 2
    s_add_u32 s7, s7, s72
    s_mul_i32 s7, s7, 14
    v_add_u32 v20, s7, v20
    v_lshlrev_b32 v23, 15, v176
    v_and_b32 v21, 3, v20
    v_lshl_add_u32 v23, v21, 6, v23
    v_bfe_u32 v21, v20, 2, 2
    v_lshl_add_u32 v23, v21, 4, v23
    v_lshrrev_b32 v21, 4, v20
    v_lshl_add_u32 v18, v21, 8, v23
    v_and_b32 v21, 3, v21
    v_cmp_eq_u32 s[68:69], 3, v21
    v_lshrrev_b32 v21, 6, v20
    v_lshl_add_u32 v23, v21, 8, v23
    s_mov_b32 s80, 81920
    s_mov_b32 s81, 89088
    s_mov_b32 s65, 200704
    s_mov_b32 s66, 202496
    s_min_u32 s7, s5, 6
    s_lshl_b32 s7, s7, 7
    s_add_u32 s82, s7, 8192
    s_cmp_ge_u32 s74, 120
    s_cselect_b32 s6, 8, 0
    v_mov_b32 v20, 0
    s_mov_b32 s77, 262144
L_kw:
    ds_read_b32 v21, v20 offset:4616
    s_waitcnt lgkmcnt(0)
    v_readfirstlane_b32 s7, v21
    s_sub_u32 s77, s77, 1
    s_cbranch_scc1 L_kw_go
    s_cmp_ge_u32 s7, s6
    s_cbranch_scc1 L_kw_go
    s_sleep 1
    s_branch L_kw
L_kw_go:
    s_mov_b32 s77, 262144
    s_branch L_gpoll
L_gagain:
    s_cmp_lg_u32 s77, 262138
    s_cbranch_scc1 L_gpoll
    s_mov_b64 exec, 0xff
    buffer_store_dwordx4 v[40:43], v181, s[56:59], s85 offen sc1
    s_mov_b64 exec, -1
L_gpoll:
    buffer_load_dwordx4 v[184:187], v181, s[56:59], s78 offen sc1
    buffer_load_dwordx4 v[188:191], v181, s[56:59], s79 offen sc1
    buffer_load_dwordx4 v[192:195], v19, s[56:59], s84 offen sc1
    buffer_load_dwordx4 v[196:199], v18, s[56:59], s80 offen sc1
    buffer_load_dwordx4 v[200:203], v18, s[56:59], s81 offen sc1
    buffer_load_dwordx4 v[204:207], v22, s[56:59], s82 offen sc1
    buffer_load_dwordx4 v[208:211], v24, s[56:59], s64 offen sc1
    buffer_load_dwordx4 v[212:215], v23, s[56:59], s65 offen sc1
    buffer_load_dwordx4 v[216:219], v23, s[56:59], s66 offen sc1
    s_waitcnt vmcnt(0)
    v_xor_b32 v184, v8, v184
    v_xor_b32 v185, v9, v185
    v_xor_b32 v186, v10, v186
    v_xor_b32 v187, v11, v187
    v_xor_b32 v188, v8, v188
    v_xor_b32 v189, v9, v189
    v_xor_b32 v190, v10, v190
    v_xor_b32 v191, v11, v191
    v_xor_b32 v192, v8, v192
    v_xor_b32 v193, v9, v193
    v_xor_b32 v194, v10, v194
    v_xor_b32 v195, v11, v195
    v_xor_b32 v196, v8, v196
    v_xor_b32 v197, v9, v197
    v_xor_b32 v198, v10, v198
    v_xor_b32 v199, v11, v199
    v_xor_b32 v200, v8, v200
    v_xor_b32 v201, v9, v201
    v_xor_b32 v202, v10, v202
    v_xor_b32 v203, v11, v203
    v_xor_b32 v204, v8, v204
    v_xor_b32 v205, v9, v205
    v_xor_b32 v206, v10, v206
    v_xor_b32 v207, v11, v207
    v_xor_b32 v208, v8, v208
    v_xor_b32 v209, v9, v209
    v_xor_b32 v210, v10, v210
    v_xor_b32 v211, v11, v211
    v_xor_b32 v212, v8, v212
    v_xor_b32 v213, v9, v213
    v_xor_b32 v214, v10, v214
    v_xor_b32 v215, v11, v215
    v_xor_b32 v216, v8, v216
    v_xor_b32 v217, v9, v217
    v_xor_b32 v218, v10, v218
    v_xor_b32 v219, v11, v219
    v_or3_b32 v20, v184, v185, v186
    v_or3_b32 v20, v20, v187, v188
    v_or3_b32 v20, v20, v189, v190
    v_or3_b32 v20, v20, v191, v192
    v_or3_b32 v20, v20, v193, v194
    v_or3_b32 v20, v20, v195, v196
    v_or3_b32 v20, v20, v197, v198
    v_or3_b32 v20, v20, v199, v200
    v_or3_b32 v20, v20, v201, v202
    v_or3_b32 v20, v20, v203, v204
    v_or3_b32 v20, v20, v205, v206
    v_or3_b32 v20, v20, v207, v208
    v_or3_b32 v20, v20, v209, v210
    v_or3_b32 v20, v20, v211, v212
    v_or3_b32 v20, v20, v213, v214
    v_or3_b32 v20, v20, v215, v216
    v_or3_b32 v20, v20, v217, v218
    v_or_b32 v20, v20, v219
    v_and_b32 v20, 0xff, v20
    v_cmp_ne_u32 vcc, 0, v20
    s_sub_u32 s77, s77, 1
    s_cbranch_scc1 L_ggo
    s_cbranch_vccnz L_gagain
L_ggo:
    s_mov_b32 exec_lo, 0
    s_mov_b32 exec_hi, 0xffff0000
    v_add_f32 v184, v184, v208
    v_add_f32 v185, v185, v209
    v_add_f32 v186, v186, v210
    v_add_f32 v187, v187, v211
    s_mov_b64 exec, s[68:69]
    v_add_f32 v196, v196, v212
    v_add_f32 v197, v197, v213
    v_add_f32 v198, v198, v214
    v_add_f32 v199, v199, v215
    v_add_f32 v200, v200, v216
    v_add_f32 v201, v201, v217
    v_add_f32 v202, v202, v218
    v_add_f32 v203, v203, v219
    s_mov_b64 exec, -1
    v_cvt_pk_bf16_f32 v32, v184, v185
    v_cvt_pk_bf16_f32 v33, v186, v187
    v_cvt_pk_bf16_f32 v34, v188, v189
    v_cvt_pk_bf16_f32 v35, v190, v191
    ds_write_b64 v17, v[32:33] offset:0
    ds_write_b64 v17, v[34:35] offset:512
    v_mov_b32 v177, 0
    v_mov_b32 v178, 1
    ds_write_b32 v177, v0 offset:4628
    v_and_b32 v192, 0xf0000, v192
    v_cmp_ne_u32 vcc, s83, v192
    s_waitcnt lgkmcnt(0)
    ds_write_b32 v177, v178 offset:4608
    v_mov_b32 v179, 1
    s_cbranch_vccz L_mode
    v_mov_b32 v40, -1
    v_mov_b32 v41, -1
    v_mov_b32 v42, -1
    v_mov_b32 v43, -1
    s_lshl_b32 s7, s73, 5
    s_add_u32 s7, s7, s27
    s_lshl_b32 s7, s7, 10
    s_add_u32 s7, s7, 327680
    buffer_store_dwordx4 v[40:43], v181, s[56:59], s7 offen sc1
    s_cmp_lg_u32 s27, 31
    s_cbranch_scc1 L_nosclr2
    s_lshl_b32 s7, s73, 8
    s_add_u32 s7, s7, 4096
    s_mov_b64 exec, 0xffff
    buffer_store_dwordx4 v[40:43], v181, s[56:59], s7 offen sc1
    s_mov_b64 exec, -1
L_nosclr2:
    s_waitcnt vmcnt(0)
    s_or_b32 s7, s83, 0x100000
    v_or_b32 v40, s7, v8
    v_or_b32 v41, s7, v9
    v_or_b32 v42, s7, v10
    v_or_b32 v43, s7, v11
    s_mov_b64 exec, 0xff
    buffer_store_dwordx4 v[40:43], v181, s[56:59], s85 offen sc1
    s_mov_b64 exec, -1
    s_mov_b32 s77, 262144
L_x2poll:
    buffer_load_dwordx4 v[192:195], v19, s[56:59], s84 offen sc1
    s_waitcnt vmcnt(0)
    v_and_b32 v192, v192, v193
    v_and_b32 v194, v194, v195
    v_and_b32 v192, v192, v194
    v_and_b32 v192, 0x100000, v192
    v_cmp_eq_u32 vcc, 0, v192
    s_sub_u32 s77, s77, 1
    s_cbranch_scc1 L_x2go
    s_cbranch_vccz L_x2go
    s_sleep 2
    s_branch L_x2poll
L_x2go:
    v_mov_b32 v179, 0
L_mode:
    ds_write_b32 v177, v179 offset:4624
    v_cmp_gt_u32 vcc, 14, v180
    v_cvt_pk_bf16_f32 v196, v196, v196
    v_cvt_pk_bf16_f32 v197, v197, v197
    v_cvt_pk_bf16_f32 v198, v198, v198
    v_cvt_pk_bf16_f32 v199, v199, v199
    v_cvt_pk_bf16_f32 v200, v200, v200
    v_cvt_pk_bf16_f32 v201, v201, v201
    v_cvt_pk_bf16_f32 v202, v202, v202
    v_cvt_pk_bf16_f32 v203, v203, v203
    v_and_b32 v196, 0xffff0000, v196
    v_and_b32 v197, 0xffff0000, v197
    v_and_b32 v198, 0xffff0000, v198
    v_and_b32 v199, 0xffff0000, v199
    v_and_b32 v200, 0xffff0000, v200
    v_and_b32 v201, 0xffff0000, v201
    v_and_b32 v202, 0xffff0000, v202
    v_and_b32 v203, 0xffff0000, v203
    v_max_f32 v196, 0, v196
    v_max_f32 v197, 0, v197
    v_max_f32 v198, 0, v198
    v_max_f32 v199, 0, v199
    v_mul_f32 v196, v196, v200
    v_mul_f32 v197, v197, v201
    v_mul_f32 v198, v198, v202
    v_mul_f32 v199, v199, v203
    v_cvt_pk_bf16_f32 v36, v196, v197
    v_cvt_pk_bf16_f32 v37, v198, v199
    v_cndmask_b32 v36, 0, v36, vcc
    v_cndmask_b32 v37, 0, v37, vcc
    v_lshlrev_b32 v20, 3, v1
    ds_write_b64 v20, v[36:37] offset:4864
    s_setprio 0
    s_branch L_issueV
.fill 1024, 4, 0xbf800000
.section .rodata,"a"
.p2align 6
.amdhsa_kernel parallel_sum__sliding_block_cached__glu_gated_reglu__decode_kernel
  .amdhsa_next_free_vgpr 256
  .amdhsa_next_free_sgpr 102
  .amdhsa_accum_offset 256
  .amdhsa_group_segment_fixed_size 0
  .amdhsa_kernarg_size 96
  .amdhsa_user_sgpr_count 2
  .amdhsa_user_sgpr_kernarg_segment_ptr 1
  .amdhsa_system_sgpr_workgroup_id_x 1
  .amdhsa_float_denorm_mode_32 3
.end_amdhsa_kernel
```
